```python
import torch

def _softmax(x, axis=-1):
    return torch.softmax(x, dim=axis)

def _gelu(x):
    return torch.nn.functional.gelu(x, approximate='tanh')

def _silu(x):
    return torch.nn.functional.silu(x)

def _sigmoid(x):
    return torch.sigmoid(x)

def _layernorm(x, axis=-1, eps=1e-05):
    m = x.mean(dim=axis, keepdim=True)
    v = x.var(dim=axis, keepdim=True, unbiased=False)
    return (x - m) / torch.sqrt(v + eps)

def _scatter_add(tgt, idx, src, axis=0):
    return tgt.clone().index_add_(axis, idx, src)

def _segment_sum(src, seg, n):
    out = torch.zeros((n,) + src.shape[1:], dtype=src.dtype)
    return out.index_add_(0, seg, src)

def _pad(x, pw):
    flat = tuple((v for pair in reversed(pw) for v in pair))
    return torch.nn.functional.pad(x, flat)
kernel_name = 'adaLN_cond__sliding_block_cached__geglu_ffn__decode'

def setup_inputs():

    _w = lambda a: (lambda t: t.to(torch.bfloat16) if t.is_floating_point() else t)(torch.as_tensor(a))

    def _A_setup():
        B, Sq, D = (1, 1, 640)
        Hq, Hkv, Sk, Dh = (32, 32, 32768, 192)
        assert Hq % Hkv == 0, (Hq, Hkv)
        return {'x': _w((lambda *s: torch.randn(*s, dtype=torch.bfloat16) * 0.1)(B, Sq, D)), 'k_cache': _w((lambda *s: torch.randn(*s, dtype=torch.bfloat16) * 0.8)(B, Hkv, Sk, Dh)), 'v_cache': _w((lambda *s: torch.randn(*s, dtype=torch.bfloat16) * 1.6)(B, Hkv, Sk, Dh)), 'wq': _w((lambda *s: torch.randn(*s, dtype=torch.bfloat16) * 0.8)(D, Hq * Dh) * D ** (-0.5)), 'wo': _w((lambda *s: torch.randn(*s, dtype=torch.bfloat16) * 1.6)(Hq * Dh, D) * (Hq * Dh) ** (-0.5))}
    _A_in = _A_setup()

    def _B_setup():
        B, S, D, F = (1, 1, 640, 1536)
        return {'x': _w((lambda *s: torch.randn(*s, dtype=torch.bfloat16) * 0.1)(B, S, D)), 'w_gate': _w((lambda *s: torch.randn(*s, dtype=torch.bfloat16) * 0.1)(D, F)), 'w_up': _w((lambda *s: torch.randn(*s, dtype=torch.bfloat16) * 0.1)(D, F)), 'w_down': _w((lambda *s: torch.randn(*s, dtype=torch.bfloat16) * 0.1)(F, D))}
    _B_in = _B_setup()
    return {'A_x': _A_in['x'], 'A_k_cache': _A_in['k_cache'], 'A_v_cache': _A_in['v_cache'], 'A_wq': _A_in['wq'], 'A_wo': _A_in['wo'], 'B_x': _B_in['x'], 'B_w_gate': _B_in['w_gate'], 'B_w_up': _B_in['w_up'], 'B_w_down': _B_in['w_down'], 'c': _w((lambda *s: torch.randn(*s, dtype=torch.bfloat16) * 0.8)(1, 640) * 8.0), 'w_mod': _w((lambda *s: torch.randn(*s, dtype=torch.bfloat16) * 0.8)(640, 6 * 640) * 640 ** (-0.5) * 8.0)}

def reference(A_x, A_k_cache, A_v_cache, A_wq, A_wo, B_x, B_w_gate, B_w_up, B_w_down, c, w_mod):

    def _A_ref(x, k_cache, v_cache, wq, wo):
        B, Sq, D = x.shape
        Hq, Dh = (32, 192)
        Hkv, Sk = (k_cache.shape[1], k_cache.shape[2])
        W = min(4096, max(256, Sk // 4))
        rep = Hq // Hkv
        q = (lambda x, *d: x.permute(*d))((x @ wq).reshape(B, Sq, Hq, Dh), 0, 2, 1, 3)
        k = (lambda x, n, axis: torch.repeat_interleave(x, n, dim=axis))(k_cache[:, :, Sk - W:, :], rep, axis=1)
        v = (lambda x, n, axis: torch.repeat_interleave(x, n, dim=axis))(v_cache[:, :, Sk - W:, :], rep, axis=1)
        scores = torch.einsum('bhqd,bhkd->bhqk', q, k) * Dh ** (-0.5)
        p = _softmax(scores, axis=-1)
        o = torch.einsum('bhqk,bhkd->bhqd', p, v)
        return (lambda x, *d: x.permute(*d))(o, 0, 2, 1, 3).reshape(B, Sq, Hq * Dh) @ wo

    def _B_ref(x, w_gate, w_up, w_down):
        return _gelu(x @ w_gate) * (x @ w_up) @ w_down
    x = A_x
    mod = (_silu(c) @ w_mod).reshape(c.shape[0], 6, 1, -1)
    sa, ca, ga, sb, cb, gb = (mod[:, 0].clone(), mod[:, 1].clone(), mod[:, 2].clone(), mod[:, 3].clone(), mod[:, 4].clone(), mod[:, 5].clone())
    h = _layernorm(x, axis=-1) * (1 + ca) + sa
    x = x + ga * _A_ref(h, A_k_cache, A_v_cache, A_wq, A_wo)
    h = _layernorm(x, axis=-1) * (1 + cb) + sb
    x = x + gb * _B_ref(h, B_w_gate, B_w_up, B_w_down)
    return x
```

```asm
; @launch grid=(256,1,1) block=(768,1,1) lds=89088
.amdgcn_target "amdgcn-amd-amdhsa--gfx950"
.text
.globl adaLN_cond__sliding_block_cached__geglu_ffn__decode_kernel
.p2align 8
.type adaLN_cond__sliding_block_cached__geglu_ffn__decode_kernel,@function
adaLN_cond__sliding_block_cached__geglu_ffn__decode_kernel:
L_base:
  s_load_dwordx16 s[16:31], s[0:1], 0
  s_cmpk_ge_u32 s2, 256
  s_cbranch_scc1 L_end
  v_readfirstlane_b32 s4, v0
  s_lshr_b32 s5, s2, 3
  s_and_b32 s6, s2, 7
  s_lshl2_add_u32 s5, s6, s5
  s_and_b32 s5, s5, 31
  v_lshrrev_b32 v3, 3, v0
  v_and_b32 v1, 7, v0
  v_lshlrev_b32 v1, 4, v1
  s_cmpk_lt_u32 s4, 256
  s_cbranch_scc1 L_pro2
  s_lshl_b32 s3, s5, 9
  s_add_u32 s3, s3, s6
  s_mulk_i32 s3, 24576
  v_mul_u32_u24 v4, 384, v3
  s_add_u32 s7, s3, 10997760
  v_add3_u32 v4, v4, v1, s7
  s_waitcnt lgkmcnt(0)
  global_load_dwordx4 v[8:11], v4, s[18:19] offset:0 nt
  global_load_dwordx4 v[12:15], v4, s[18:19] offset:128 nt
  global_load_dwordx4 v[16:19], v4, s[18:19] offset:256 nt
L_pro2:
  s_load_dwordx8 s[32:39], s[0:1], 64
  s_load_dwordx2 s[40:41], s[0:1], 104
  v_and_b32 v2, 63, v0
  s_lshr_b32 s4, s4, 6
  v_and_b32 v3, 7, v3
  s_mov_b32 s42, 0x200000
  s_mov_b32 s43, 0x20000
  s_mov_b32 s47, 0x20000
  s_mov_b32 s51, 0x20000
  s_mov_b32 s58, 1048576
  s_lshl3_add_u32 s59, s5, s6
  s_cmp_lt_u32 s4, 4
  s_cbranch_scc0 L_strm
  s_setprio 3
  s_sub_u32 s10, s2, 96
  s_cbranch_scc1 L_cB
  s_cmp_ge_u32 s10, 80
  s_cbranch_scc1 L_rest
  s_cmp_ge_u32 s4, 2
  s_cbranch_scc1 L_cN
  s_mul_i32 s12, s10, 3277
  s_lshr_b32 s12, s12, 16
  s_mul_i32 s7, s12, 20
  s_sub_u32 s13, s10, s7
  s_lshl1_add_u32 s8, s12, s4
L_rest2:
  v_mul_u32_u24 v72, 7680, v3
  v_add_u32 v72, v72, v1
  s_mul_i32 s3, s8, 614400
  s_lshl_b32 s7, s13, 7
  s_add_u32 s3, s3, s7
  s_mov_b32 s46, 614400
  s_mov_b32 s57, 61440
  v_min_u32 v74, 39, v2
  s_mul_i32 s7, s8, 160
  v_lshl_add_u32 v74, v74, 2, s7
  s_getpc_b64 s[60:61]
L_pc0:
  s_add_u32 s60, s60, L_cA-L_pc0
  s_addc_u32 s61, s61, 0
  s_waitcnt lgkmcnt(0)
  s_add_u32 s44, s36, s3
  s_addc_u32 s45, s37, 0
  global_load_dword v82, v74, s[34:35]
  s_cmp_lt_u32 s10, 80
  s_cbranch_scc0 L_cA
L_load10:
  s_mov_b32 s56, 0
  buffer_load_dwordx4 v[8:11], v72, s[44:47], s56 offen nt
  s_add_u32 s56, s56, s57
  buffer_load_dwordx4 v[12:15], v72, s[44:47], s56 offen nt
  s_add_u32 s56, s56, s57
  buffer_load_dwordx4 v[16:19], v72, s[44:47], s56 offen nt
  s_add_u32 s56, s56, s57
  buffer_load_dwordx4 v[20:23], v72, s[44:47], s56 offen nt
  s_add_u32 s56, s56, s57
  buffer_load_dwordx4 v[24:27], v72, s[44:47], s56 offen nt
  s_add_u32 s56, s56, s57
  buffer_load_dwordx4 v[28:31], v72, s[44:47], s56 offen nt
  s_add_u32 s56, s56, s57
  buffer_load_dwordx4 v[32:35], v72, s[44:47], s56 offen nt
  s_add_u32 s56, s56, s57
  buffer_load_dwordx4 v[36:39], v72, s[44:47], s56 offen nt
  s_add_u32 s56, s56, s57
  buffer_load_dwordx4 v[40:43], v72, s[44:47], s56 offen nt
  s_add_u32 s56, s56, s57
  buffer_load_dwordx4 v[44:47], v72, s[44:47], s56 offen nt
  s_setpc_b64 s[60:61]
L_strm:
  v_mul_u32_u24 v4, 384, v3
  s_mul_i32 s3, s5, 12582912
  s_add_u32 s3, s3, 11010048
  s_lshl3_add_u32 s7, s6, s4
  s_cmpk_lt_u32 s2, 96
  s_cselect_b32 s55, 8, 8
  s_mulk_i32 s55, 24576
  s_mul_i32 s57, s7, 3072
  s_sub_u32 s57, s57, 12288
  s_mov_b32 s56, s57
  v_add_u32 v3, v1, v4
  s_mov_b32 s46, 1572864
  s_mov_b32 s50, 1572864
  s_add_u32 s44, s18, s3
  s_addc_u32 s45, s19, 0
  s_add_u32 s48, s20, s3
  s_addc_u32 s49, s21, 0
  s_sub_u32 s13, s2, 96
  s_cselect_b32 s13, 0, s13
  s_cmp_lt_u32 s13, 80
  s_cbranch_scc0 L_nb0
  s_barrier
L_nb0:
  s_add_u32 s56, s56, s55
  buffer_load_dwordx4 v[20:23], v3, s[44:47], s56 offen offset:0 nt
  v_mov_b32 v128, 0
  v_mov_b32 v129, 0
  v_mov_b32 v130, 0
  v_mov_b32 v131, 0
  v_mov_b32 v132, 0
  v_and_b32 v135, 1, v2
  v_lshlrev_b32 v135, 4, v135
  v_mov_b32 v136, 0xffff
  v_lshlrev_b32 v135, v135, v136
  v_bfe_u32 v136, v2, 1, 2
  v_cmp_eq_u32 vcc, 0, v136
  s_nop 1
  v_cndmask_b32 v4, 0, v135, vcc
  v_cmp_eq_u32 vcc, 1, v136
  s_nop 1
  v_cndmask_b32 v5, 0, v135, vcc
  v_cmp_eq_u32 vcc, 2, v136
  s_nop 1
  v_cndmask_b32 v6, 0, v135, vcc
  v_cmp_eq_u32 vcc, 3, v136
  s_nop 1
  v_cndmask_b32 v7, 0, v135, vcc
  s_mul_i32 s3, s5, 4352
  s_add_u32 s3, s3, 1572864
  s_mov_b32 s65, 0
  s_mov_b32 s67, 0
  s_waitcnt lgkmcnt(0)
  s_add_u32 s52, s40, s3
  s_addc_u32 s53, s41, 0
  s_cmp_lt_u32 s2, 96
  s_movk_i32 s10, 32
  s_cselect_b32 s10, 40, s10
  s_sub_u32 s10, 192, s10
  v_mov_b32 v0, 0
  s_cmp_lt_u32 s13, 80
  s_cbranch_scc1 L_nb1
  s_barrier
L_nb1:
  s_waitcnt vmcnt(3)
  buffer_load_dwordx4 v[24:27], v3, s[44:47], s56 offen offset:128 nt
  s_waitcnt vmcnt(3)
  buffer_load_dwordx4 v[28:31], v3, s[44:47], s56 offen offset:256 nt
  s_waitcnt vmcnt(3)
  s_add_u32 s56, s56, s55
  buffer_load_dwordx4 v[32:35], v3, s[44:47], s56 offen offset:0 nt
  s_waitcnt vmcnt(3)
  buffer_load_dwordx4 v[36:39], v3, s[44:47], s56 offen offset:128 nt
  s_waitcnt vmcnt(3)
  buffer_load_dwordx4 v[40:43], v3, s[44:47], s56 offen offset:256 nt
  s_waitcnt vmcnt(3)
  s_add_u32 s56, s56, s55
  buffer_load_dwordx4 v[44:47], v3, s[44:47], s56 offen offset:0 nt
  s_waitcnt vmcnt(3)
  buffer_load_dwordx4 v[48:51], v3, s[44:47], s56 offen offset:128 nt
  s_waitcnt vmcnt(3)
  buffer_load_dwordx4 v[52:55], v3, s[44:47], s56 offen offset:256 nt
  s_waitcnt vmcnt(3)
  s_add_u32 s56, s56, s55
  buffer_load_dwordx4 v[56:59], v3, s[44:47], s56 offen offset:0 nt
  s_waitcnt vmcnt(3)
  buffer_load_dwordx4 v[60:63], v3, s[44:47], s56 offen offset:128 nt
  s_waitcnt vmcnt(3)
  buffer_load_dwordx4 v[64:67], v3, s[44:47], s56 offen offset:256 nt
  s_waitcnt vmcnt(3)
  buffer_load_dwordx4 v[68:71], v3, s[48:51], s57 offen offset:0 nt
  s_waitcnt vmcnt(3)
  buffer_load_dwordx4 v[72:75], v3, s[48:51], s57 offen offset:128 nt
  s_waitcnt vmcnt(3)
  buffer_load_dwordx4 v[76:79], v3, s[48:51], s57 offen offset:256 nt
  s_waitcnt vmcnt(3)
  s_add_u32 s57, s57, s55
  buffer_load_dwordx4 v[80:83], v3, s[48:51], s57 offen offset:0 nt
  s_waitcnt vmcnt(3)
  buffer_load_dwordx4 v[84:87], v3, s[48:51], s57 offen offset:128 nt
  s_waitcnt vmcnt(3)
  buffer_load_dwordx4 v[88:91], v3, s[48:51], s57 offen offset:256 nt
  s_waitcnt vmcnt(3)
  s_add_u32 s57, s57, s55
  buffer_load_dwordx4 v[92:95], v3, s[48:51], s57 offen offset:0 nt
  s_waitcnt vmcnt(3)
  buffer_load_dwordx4 v[96:99], v3, s[48:51], s57 offen offset:128 nt
  s_waitcnt vmcnt(3)
  buffer_load_dwordx4 v[100:103], v3, s[48:51], s57 offen offset:256 nt
  s_waitcnt vmcnt(3)
  s_add_u32 s57, s57, s55
  buffer_load_dwordx4 v[104:107], v3, s[48:51], s57 offen offset:0 nt
  s_waitcnt vmcnt(3)
  buffer_load_dwordx4 v[108:111], v3, s[48:51], s57 offen offset:128 nt
  s_waitcnt vmcnt(3)
  buffer_load_dwordx4 v[112:115], v3, s[48:51], s57 offen offset:256 nt
  s_waitcnt vmcnt(3)
  s_add_u32 s57, s57, s55
  buffer_load_dwordx4 v[116:119], v3, s[48:51], s57 offen offset:0 nt
  s_waitcnt vmcnt(3)
  buffer_load_dwordx4 v[120:123], v3, s[48:51], s57 offen offset:128 nt
  s_waitcnt vmcnt(3)
  buffer_load_dwordx4 v[124:127], v3, s[48:51], s57 offen offset:256 nt
L_w1:
  ds_read_b32 v135, v0 offset:1044
  s_waitcnt lgkmcnt(0)
  v_readfirstlane_b32 s3, v135
  s_cmp_ge_u32 s3, 5
  s_cbranch_scc0 L_rt63
L_d2:
  ds_read_b96 v[136:138], v0 offset:1664
  ds_read_b128 v[140:143], v1 offset:1280
  ds_read_b128 v[144:147], v1 offset:1408
  ds_read_b128 v[148:151], v1 offset:1536
  s_waitcnt vmcnt(15) lgkmcnt(0)
  v_mov_b32 v1, 1
  v_readfirstlane_b32 s14, v136
  v_readfirstlane_b32 s15, v137
  v_readfirstlane_b32 s27, v138
  s_mov_b32 s12, 1
  s_atomic_add s12, s[52:53], 0 glc
  v_dot2c_f32_bf16 v128, v8, v140
  v_dot2c_f32_bf16 v129, v20, v140
  v_dot2c_f32_bf16 v130, v32, v140
  v_dot2c_f32_bf16 v131, v44, v140
  v_dot2c_f32_bf16 v132, v56, v140
  v_dot2c_f32_bf16 v128, v9, v141
  v_dot2c_f32_bf16 v129, v21, v141
  v_dot2c_f32_bf16 v130, v33, v141
  v_dot2c_f32_bf16 v131, v45, v141
  v_dot2c_f32_bf16 v132, v57, v141
  v_dot2c_f32_bf16 v128, v10, v142
  v_dot2c_f32_bf16 v129, v22, v142
  v_dot2c_f32_bf16 v130, v34, v142
  v_dot2c_f32_bf16 v131, v46, v142
  v_dot2c_f32_bf16 v132, v58, v142
  v_dot2c_f32_bf16 v128, v11, v143
  v_dot2c_f32_bf16 v129, v23, v143
  v_dot2c_f32_bf16 v130, v35, v143
  v_dot2c_f32_bf16 v131, v47, v143
  v_dot2c_f32_bf16 v132, v59, v143
  v_dot2c_f32_bf16 v128, v12, v144
  v_dot2c_f32_bf16 v129, v24, v144
  v_dot2c_f32_bf16 v130, v36, v144
  v_dot2c_f32_bf16 v131, v48, v144
  v_dot2c_f32_bf16 v132, v60, v144
  v_dot2c_f32_bf16 v128, v13, v145
  v_dot2c_f32_bf16 v129, v25, v145
  v_dot2c_f32_bf16 v130, v37, v145
  v_dot2c_f32_bf16 v131, v49, v145
  v_dot2c_f32_bf16 v132, v61, v145
  v_dot2c_f32_bf16 v128, v14, v146
  v_dot2c_f32_bf16 v129, v26, v146
  v_dot2c_f32_bf16 v130, v38, v146
  v_dot2c_f32_bf16 v131, v50, v146
  v_dot2c_f32_bf16 v132, v62, v146
  v_dot2c_f32_bf16 v128, v15, v147
  v_dot2c_f32_bf16 v129, v27, v147
  v_dot2c_f32_bf16 v130, v39, v147
  v_dot2c_f32_bf16 v131, v51, v147
  v_dot2c_f32_bf16 v132, v63, v147
  v_dot2c_f32_bf16 v128, v16, v148
  v_dot2c_f32_bf16 v129, v28, v148
  v_dot2c_f32_bf16 v130, v40, v148
  v_dot2c_f32_bf16 v131, v52, v148
  v_dot2c_f32_bf16 v132, v64, v148
  v_dot2c_f32_bf16 v128, v17, v149
  v_dot2c_f32_bf16 v129, v29, v149
  v_dot2c_f32_bf16 v130, v41, v149
  v_dot2c_f32_bf16 v131, v53, v149
  v_dot2c_f32_bf16 v132, v65, v149
  v_dot2c_f32_bf16 v128, v18, v150
  v_dot2c_f32_bf16 v129, v30, v150
  v_dot2c_f32_bf16 v130, v42, v150
  v_dot2c_f32_bf16 v131, v54, v150
  v_dot2c_f32_bf16 v132, v66, v150
  v_dot2c_f32_bf16 v128, v19, v151
  v_dot2c_f32_bf16 v129, v31, v151
  v_dot2c_f32_bf16 v130, v43, v151
  v_dot2c_f32_bf16 v131, v55, v151
  v_dot2c_f32_bf16 v132, v67, v151
  v_add_f32 v128, v128, v128 quad_perm:[1,0,3,2] row_mask:0xf bank_mask:0xf
  v_add_f32 v129, v129, v129 quad_perm:[1,0,3,2] row_mask:0xf bank_mask:0xf
  v_add_f32 v130, v130, v130 quad_perm:[1,0,3,2] row_mask:0xf bank_mask:0xf
  v_add_f32 v131, v131, v131 quad_perm:[1,0,3,2] row_mask:0xf bank_mask:0xf
  v_add_f32 v132, v132, v132 quad_perm:[1,0,3,2] row_mask:0xf bank_mask:0xf
  v_add_f32 v128, v128, v128 quad_perm:[2,3,0,1] row_mask:0xf bank_mask:0xf
  v_add_f32 v129, v129, v129 quad_perm:[2,3,0,1] row_mask:0xf bank_mask:0xf
  v_add_f32 v130, v130, v130 quad_perm:[2,3,0,1] row_mask:0xf bank_mask:0xf
  v_add_f32 v131, v131, v131 quad_perm:[2,3,0,1] row_mask:0xf bank_mask:0xf
  v_add_f32 v132, v132, v132 quad_perm:[2,3,0,1] row_mask:0xf bank_mask:0xf
  v_add_f32 v128, v128, v128 row_half_mirror row_mask:0xf bank_mask:0xf
  v_add_f32 v129, v129, v129 row_half_mirror row_mask:0xf bank_mask:0xf
  v_add_f32 v130, v130, v130 row_half_mirror row_mask:0xf bank_mask:0xf
  v_add_f32 v131, v131, v131 row_half_mirror row_mask:0xf bank_mask:0xf
  v_add_f32 v132, v132, v132 row_half_mirror row_mask:0xf bank_mask:0xf
  v_cvt_pk_bf16_f32 v135, v128, v129
  v_cvt_pk_bf16_f32 v136, v130, v131
  v_cvt_pk_bf16_f32 v137, v132, v132
  v_lshlrev_b32 v128, 16, v135
  v_and_b32 v129, 0xffff0000, v135
  v_lshlrev_b32 v130, 16, v136
  v_and_b32 v131, 0xffff0000, v136
  v_lshlrev_b32 v132, 16, v137
  v_mul_f32 v128, 0x3d93cd3a, v128
  v_mul_f32 v129, 0x3d93cd3a, v129
  v_mul_f32 v130, 0x3d93cd3a, v130
  v_mul_f32 v131, 0x3d93cd3a, v131
  v_mul_f32 v132, 0x3d93cd3a, v132
  v_cvt_pk_bf16_f32 v135, v128, v129
  v_cvt_pk_bf16_f32 v136, v130, v131
  v_cvt_pk_bf16_f32 v137, v132, v132
  v_lshlrev_b32 v128, 16, v135
  v_and_b32 v129, 0xffff0000, v135
  v_lshlrev_b32 v130, 16, v136
  v_and_b32 v131, 0xffff0000, v136
  v_lshlrev_b32 v132, 16, v137
  v_max3_f32 v135, v128, v129, v130
  v_max_f32 v135, v135, v131
  v_max_f32 v135, v135, v132
  s_nop 1
  v_max_f32 v135, v135, v135 row_ror:8 row_mask:0xf bank_mask:0xf
  s_nop 1
  v_max_f32 v135, v135, v135 row_bcast:15 row_mask:0xa bank_mask:0xf
  s_nop 1
  v_max_f32 v135, v135, v135 row_bcast:31 row_mask:0xc bank_mask:0xf
  s_nop 0
  v_readlane_b32 s8, v135, 63
  s_nop 1
  v_subrev_f32 v128, s8, v128
  v_subrev_f32 v129, s8, v129
  v_subrev_f32 v130, s8, v130
  v_subrev_f32 v131, s8, v131
  v_subrev_f32 v132, s8, v132
  v_mul_f32 v128, 0x3fb8aa3b, v128
  v_mul_f32 v129, 0x3fb8aa3b, v129
  v_mul_f32 v130, 0x3fb8aa3b, v130
  v_mul_f32 v131, 0x3fb8aa3b, v131
  v_mul_f32 v132, 0x3fb8aa3b, v132
  v_exp_f32 v128, v128
  v_exp_f32 v129, v129
  v_exp_f32 v130, v130
  v_exp_f32 v131, v131
  v_exp_f32 v132, v132
  v_add_f32 v134, v128, v129
  v_add_f32 v134, v134, v130
  v_add_f32 v134, v134, v131
  v_add_f32 v134, v134, v132
  v_cvt_pk_bf16_f32 v128, v128, v128
  v_cvt_pk_bf16_f32 v129, v129, v129
  v_cvt_pk_bf16_f32 v130, v130, v130
  v_cvt_pk_bf16_f32 v131, v131, v131
  v_cvt_pk_bf16_f32 v132, v132, v132
  v_and_b32 v61, 7, v2
  v_lshrrev_b32 v65, 5, v2
  v_lshlrev_b32 v60, 3, v61
  v_and_b32 v62, 32, v2
  v_xor_b32 v60, v60, v62
  v_lshlrev_b32 v62, 5, v61
  v_and_b32 v63, 16, v2
  s_mul_i32 s3, s4, 768
  v_add3_u32 v56, v62, v63, s3
  v_lshl_add_u32 v56, v65, 3, v56
  v_and_b32 v66, 31, v2
  s_bfe_u32 s3, s5, 0x30001
  s_lshr_b32 s7, s5, 4
  s_lshl1_add_u32 s3, s3, s7
  s_and_b32 s7, s5, 1
  s_lshl1_add_u32 s3, s3, s7
  s_lshl_b32 s3, s3, 12
  s_add_u32 s3, s3, 98304
  s_lshl_b32 s7, s6, 9
  s_add_u32 s3, s3, s7
  s_xor_b32 s3, s3, s27
  v_lshl_add_u32 v57, v66, 4, s3
  v_lshl_add_u32 v57, v65, 3, v57
  v_mul_u32_u24 v58, 24, v66
  v_mul_u32_u24 v65, 3072, v65
  s_movk_i32 s3, 5120
  v_add3_u32 v58, v58, v65, s3
  v_add_u32 v61, 1536, v58
  v_mov_b32 v62, 0xffff
  v_and_b32 v66, 47, v2
  v_subrev_u32 v66, 32, v66
  v_cmp_gt_u32 vcc, 6, v66
  v_add_u32 v66, 2, v66
  s_nop 0
  v_cndmask_b32 v66, 12, v66, vcc
  s_mov_b32 s3, 0x0c000c0c
  v_lshl_or_b32 v63, v66, 16, s3
  v_cndmask_b32 v66, 16, 24, vcc
  v_lshlrev_b32 v64, v66, s14
  s_lshl_b32 s3, s4, 3
  v_mov_b32 v59, s3
  s_mov_b32 s62, 0x00ff00ff
  s_mov_b32 s63, 0x00ff00ff
  s_waitcnt vmcnt(3)
  v_and_b32 v164, v128, v4
  v_and_b32 v165, v128, v5
  v_and_b32 v166, v128, v6
  v_and_b32 v167, v128, v7
  s_nop 1
  v_mfma_f32_16x16x32_bf16 v[152:155], v[164:167], v[68:71], 0
  v_mfma_f32_16x16x32_bf16 v[156:159], v[164:167], v[72:75], 0
  v_mfma_f32_16x16x32_bf16 v[160:163], v[164:167], v[76:79], 0
  v_and_b32 v164, v129, v4
  v_and_b32 v165, v129, v5
  v_and_b32 v166, v129, v6
  v_and_b32 v167, v129, v7
  s_nop 1
  v_mfma_f32_16x16x32_bf16 v[152:155], v[164:167], v[80:83], v[152:155]
  v_mfma_f32_16x16x32_bf16 v[156:159], v[164:167], v[84:87], v[156:159]
  v_mfma_f32_16x16x32_bf16 v[160:163], v[164:167], v[88:91], v[160:163]
  v_and_b32 v164, v130, v4
  v_and_b32 v165, v130, v5
  v_and_b32 v166, v130, v6
  v_and_b32 v167, v130, v7
  s_nop 1
  v_mfma_f32_16x16x32_bf16 v[152:155], v[164:167], v[92:95], v[152:155]
  v_mfma_f32_16x16x32_bf16 v[156:159], v[164:167], v[96:99], v[156:159]
  v_mfma_f32_16x16x32_bf16 v[160:163], v[164:167], v[100:103], v[160:163]
  v_and_b32 v164, v131, v4
  v_and_b32 v165, v131, v5
  v_and_b32 v166, v131, v6
  v_and_b32 v167, v131, v7
  s_nop 1
  v_mfma_f32_16x16x32_bf16 v[152:155], v[164:167], v[104:107], v[152:155]
  v_mfma_f32_16x16x32_bf16 v[156:159], v[164:167], v[108:111], v[156:159]
  v_mfma_f32_16x16x32_bf16 v[160:163], v[164:167], v[112:115], v[160:163]
  v_and_b32 v164, v132, v4
  v_and_b32 v165, v132, v5
  v_and_b32 v166, v132, v6
  v_and_b32 v167, v132, v7
  s_waitcnt lgkmcnt(0)
  s_mov_b32 s11, s12
  s_cmp_lt_u32 s11, 192
  s_cbranch_scc0 L_lastS
  s_mul_i32 s54, s11, 3072
  s_add_u32 s54, s54, 983040
  s_waitcnt vmcnt(2)
  buffer_load_dwordx4 v[8:11], v3, s[44:47], s54 offen offset:0 nt
  buffer_load_dwordx4 v[12:15], v3, s[44:47], s54 offen offset:128 nt
  buffer_load_dwordx4 v[16:19], v3, s[44:47], s54 offen offset:256 nt
  buffer_load_dwordx4 v[20:23], v3, s[48:51], s54 offen offset:0 nt
  buffer_load_dwordx4 v[24:27], v3, s[48:51], s54 offen offset:128 nt
  buffer_load_dwordx4 v[28:31], v3, s[48:51], s54 offen offset:256 nt
  s_waitcnt vmcnt(6)
  v_mfma_f32_16x16x32_bf16 v[152:155], v[164:167], v[116:119], v[152:155]
  v_mfma_f32_16x16x32_bf16 v[156:159], v[164:167], v[120:123], v[156:159]
  v_mfma_f32_16x16x32_bf16 v[160:163], v[164:167], v[124:127], v[160:163]
  s_branch L_loopA
L_loop:
  s_waitcnt lgkmcnt(0)
  s_mov_b32 s11, s12
  s_cmp_lt_u32 s11, 192
  s_cbranch_scc0 L_lastB
  s_mul_i32 s54, s11, 3072
  s_add_u32 s54, s54, 983040
  s_waitcnt vmcnt(2)
  buffer_load_dwordx4 v[8:11], v3, s[44:47], s54 offen offset:0 nt
  buffer_load_dwordx4 v[12:15], v3, s[44:47], s54 offen offset:128 nt
  buffer_load_dwordx4 v[16:19], v3, s[44:47], s54 offen offset:256 nt
  buffer_load_dwordx4 v[20:23], v3, s[48:51], s54 offen offset:0 nt
  buffer_load_dwordx4 v[24:27], v3, s[48:51], s54 offen offset:128 nt
  buffer_load_dwordx4 v[28:31], v3, s[48:51], s54 offen offset:256 nt
  s_waitcnt vmcnt(6)
  v_mfma_f32_16x16x32_bf16 v[152:155], v[164:167], v[44:47], v[152:155]
  v_mfma_f32_16x16x32_bf16 v[156:159], v[164:167], v[48:51], v[156:159]
  v_mfma_f32_16x16x32_bf16 v[160:163], v[164:167], v[52:55], v[160:163]
L_loopA:
  v_mov_b32 v135, 0
  v_mov_b32 v136, 0
  s_waitcnt vmcnt(5)
  v_dot2c_f32_bf16 v135, v8, v140
  v_dot2c_f32_bf16 v136, v9, v141
  v_dot2c_f32_bf16 v135, v10, v142
  v_dot2c_f32_bf16 v136, v11, v143
  s_waitcnt vmcnt(4)
  s_movk_i32 s12, 192
  s_cmp_lt_u32 s11, s10
  s_cbranch_scc0 L_nt3
  s_mov_b32 s12, 1
  s_atomic_add s12, s[52:53], 0 glc
L_nt3:
  v_dot2c_f32_bf16 v135, v12, v144
  v_dot2c_f32_bf16 v136, v13, v145
  v_dot2c_f32_bf16 v135, v14, v146
  v_dot2c_f32_bf16 v136, v15, v147
  s_waitcnt vmcnt(3)
  v_dot2c_f32_bf16 v135, v16, v148
  v_dot2c_f32_bf16 v136, v17, v149
  v_dot2c_f32_bf16 v135, v18, v150
  v_dot2c_f32_bf16 v136, v19, v151
  s_nop 2
  v_add_f32 v135, v135, v136
  s_nop 1
  v_add_f32 v135, v135, v135 quad_perm:[1,0,3,2] row_mask:0xf bank_mask:0xf
  s_nop 1
  v_add_f32 v135, v135, v135 quad_perm:[2,3,0,1] row_mask:0xf bank_mask:0xf
  s_nop 1
  v_add_f32 v135, v135, v135 row_half_mirror row_mask:0xf bank_mask:0xf
  v_cvt_pk_bf16_f32 v135, v135, v135
  v_and_b32 v135, 0xffff0000, v135
  v_mul_f32 v135, 0x3d93cd3a, v135
  v_cvt_pk_bf16_f32 v135, v135, v135
  v_and_b32 v135, 0xffff0000, v135
  v_cmp_lt_f32 vcc, s8, v135
  s_cbranch_vccnz L_ncA
L_nmA:
  v_subrev_f32 v135, s8, v135
  v_mul_f32 v135, 0x3fb8aa3b, v135
  v_exp_f32 v135, v135
  s_nop 0
  v_add_f32 v134, v134, v135
  v_cvt_pk_bf16_f32 v135, v135, v135
  v_and_b32 v164, v135, v4
  v_and_b32 v165, v135, v5
  v_and_b32 v166, v135, v6
  v_and_b32 v167, v135, v7
  s_waitcnt lgkmcnt(0)
  s_mov_b32 s11, s12
  s_cmp_lt_u32 s11, 192
  s_cbranch_scc0 L_lastA
  s_mul_i32 s54, s11, 3072
  s_add_u32 s54, s54, 983040
  s_waitcnt vmcnt(2)
  buffer_load_dwordx4 v[32:35], v3, s[44:47], s54 offen offset:0 nt
  buffer_load_dwordx4 v[36:39], v3, s[44:47], s54 offen offset:128 nt
  buffer_load_dwordx4 v[40:43], v3, s[44:47], s54 offen offset:256 nt
  buffer_load_dwordx4 v[44:47], v3, s[48:51], s54 offen offset:0 nt
  buffer_load_dwordx4 v[48:51], v3, s[48:51], s54 offen offset:128 nt
  buffer_load_dwordx4 v[52:55], v3, s[48:51], s54 offen offset:256 nt
  s_waitcnt vmcnt(6)
  v_mfma_f32_16x16x32_bf16 v[152:155], v[164:167], v[20:23], v[152:155]
  v_mfma_f32_16x16x32_bf16 v[156:159], v[164:167], v[24:27], v[156:159]
  v_mfma_f32_16x16x32_bf16 v[160:163], v[164:167], v[28:31], v[160:163]
L_loopB:
  v_mov_b32 v135, 0
  v_mov_b32 v136, 0
  s_waitcnt vmcnt(5)
  v_dot2c_f32_bf16 v135, v32, v140
  v_dot2c_f32_bf16 v136, v33, v141
  v_dot2c_f32_bf16 v135, v34, v142
  v_dot2c_f32_bf16 v136, v35, v143
  s_waitcnt vmcnt(4)
  s_movk_i32 s12, 192
  s_cmp_lt_u32 s11, s10
  s_cbranch_scc0 L_nt4
  s_mov_b32 s12, 1
  s_atomic_add s12, s[52:53], 0 glc
L_nt4:
  v_dot2c_f32_bf16 v135, v36, v144
  v_dot2c_f32_bf16 v136, v37, v145
  v_dot2c_f32_bf16 v135, v38, v146
  v_dot2c_f32_bf16 v136, v39, v147
  s_waitcnt vmcnt(3)
  v_dot2c_f32_bf16 v135, v40, v148
  v_dot2c_f32_bf16 v136, v41, v149
  v_dot2c_f32_bf16 v135, v42, v150
  v_dot2c_f32_bf16 v136, v43, v151
  s_nop 2
  v_add_f32 v135, v135, v136
  s_nop 1
  v_add_f32 v135, v135, v135 quad_perm:[1,0,3,2] row_mask:0xf bank_mask:0xf
  s_nop 1
  v_add_f32 v135, v135, v135 quad_perm:[2,3,0,1] row_mask:0xf bank_mask:0xf
  s_nop 1
  v_add_f32 v135, v135, v135 row_half_mirror row_mask:0xf bank_mask:0xf
  v_cvt_pk_bf16_f32 v135, v135, v135
  v_and_b32 v135, 0xffff0000, v135
  v_mul_f32 v135, 0x3d93cd3a, v135
  v_cvt_pk_bf16_f32 v135, v135, v135
  v_and_b32 v135, 0xffff0000, v135
  v_cmp_lt_f32 vcc, s8, v135
  s_cbranch_vccnz L_ncB
L_nmB:
  v_subrev_f32 v135, s8, v135
  v_mul_f32 v135, 0x3fb8aa3b, v135
  v_exp_f32 v135, v135
  s_nop 0
  v_add_f32 v134, v134, v135
  v_cvt_pk_bf16_f32 v135, v135, v135
  v_and_b32 v164, v135, v4
  v_and_b32 v165, v135, v5
  v_and_b32 v166, v135, v6
  v_and_b32 v167, v135, v7
  s_branch L_loop
L_ncA:
  s_call_b64 s[60:61], L_newmax
  s_branch L_nmA
L_ncB:
  s_call_b64 s[60:61], L_newmax
  s_branch L_nmB
L_newmax:
  v_mov_b32 v136, v135
  s_nop 1
  v_max_f32 v136, v136, v136 row_ror:8 row_mask:0xf bank_mask:0xf
  s_nop 1
  v_max_f32 v136, v136, v136 row_bcast:15 row_mask:0xa bank_mask:0xf
  s_nop 1
  v_max_f32 v136, v136, v136 row_bcast:31 row_mask:0xc bank_mask:0xf
  v_mov_b32 v137, s8
  v_readlane_b32 s8, v136, 63
  s_nop 1
  v_subrev_f32 v137, s8, v137
  v_mul_f32 v137, 0x3fb8aa3b, v137
  v_exp_f32 v137, v137
  s_nop 0
  v_mul_f32 v134, v134, v137
  v_mul_f32 v152, v152, v137
  v_mul_f32 v153, v153, v137
  v_mul_f32 v154, v154, v137
  v_mul_f32 v155, v155, v137
  v_mul_f32 v156, v156, v137
  v_mul_f32 v157, v157, v137
  v_mul_f32 v158, v158, v137
  v_mul_f32 v159, v159, v137
  v_mul_f32 v160, v160, v137
  v_mul_f32 v161, v161, v137
  v_mul_f32 v162, v162, v137
  v_mul_f32 v163, v163, v137
  s_setpc_b64 s[60:61]
L_lastS:
  s_waitcnt vmcnt(2)
  v_mfma_f32_16x16x32_bf16 v[152:155], v[164:167], v[116:119], v[152:155]
  s_waitcnt vmcnt(1)
  v_mfma_f32_16x16x32_bf16 v[156:159], v[164:167], v[120:123], v[156:159]
  s_waitcnt vmcnt(0)
  v_mfma_f32_16x16x32_bf16 v[160:163], v[164:167], v[124:127], v[160:163]
  s_branch L_epi
L_lastA:
  s_waitcnt vmcnt(2)
  v_mfma_f32_16x16x32_bf16 v[152:155], v[164:167], v[20:23], v[152:155]
  s_waitcnt vmcnt(1)
  v_mfma_f32_16x16x32_bf16 v[156:159], v[164:167], v[24:27], v[156:159]
  s_waitcnt vmcnt(0)
  v_mfma_f32_16x16x32_bf16 v[160:163], v[164:167], v[28:31], v[160:163]
  s_branch L_epi
L_lastB:
  s_waitcnt vmcnt(2)
  v_mfma_f32_16x16x32_bf16 v[152:155], v[164:167], v[44:47], v[152:155]
  s_waitcnt vmcnt(1)
  v_mfma_f32_16x16x32_bf16 v[156:159], v[164:167], v[48:51], v[156:159]
  s_waitcnt vmcnt(0)
  v_mfma_f32_16x16x32_bf16 v[160:163], v[164:167], v[52:55], v[160:163]
L_epi:
  s_mov_b64 exec, 1
  ds_add_u32 v0, v1 offset:1024
  s_mov_b64 exec, -1
  v_add_f32 v134, v134, v134 row_ror:8 row_mask:0xf bank_mask:0xf
  v_mov_b32 v133, s8
  s_nop 0
  v_add_f32 v134, v134, v134 row_bcast:15 row_mask:0xa bank_mask:0xf
  v_permlane32_swap_b32 v152, v154
  s_nop 0
  v_add_f32 v134, v134, v134 row_bcast:31 row_mask:0xc bank_mask:0xf
  v_permlane32_swap_b32 v153, v155
  v_permlane32_swap_b32 v156, v158
  v_permlane32_swap_b32 v157, v159
  v_permlane32_swap_b32 v160, v162
  v_permlane32_swap_b32 v161, v163
  v_add_f32 v152, v154, v152 row_ror:8 row_mask:0xf bank_mask:0xf
  v_add_f32 v153, v155, v153 row_ror:8 row_mask:0xf bank_mask:0xf
  v_add_f32 v156, v158, v156 row_ror:8 row_mask:0xf bank_mask:0xf
  v_add_f32 v157, v159, v157 row_ror:8 row_mask:0xf bank_mask:0xf
  v_add_f32 v160, v162, v160 row_ror:8 row_mask:0xf bank_mask:0xf
  v_add_f32 v161, v163, v161 row_ror:8 row_mask:0xf bank_mask:0xf
  s_mov_b64 exec, s[62:63]
  ds_write_b64 v56, v[152:153] offset:2048
  ds_write_b64 v56, v[156:157] offset:2304
  ds_write_b64 v56, v[160:161] offset:2560
  s_lshl_b64 exec, 1, 48
  ds_write2_b32 v59, v133, v134 offset0:120 offset1:121
  ds_add_rtn_u32 v6, v0, v1 offset:1028
  s_mov_b64 exec, -1
  ds_read_b64 v[144:145], v60 offset:512
  ds_read2_b64 v[68:71], v58 offset0:0 offset1:1
  ds_read_b64 v[72:73], v58 offset:16
  ds_read2_b64 v[74:77], v58 offset0:96 offset1:97
  ds_read_b64 v[78:79], v58 offset:784
  ds_read2_b64 v[80:83], v61 offset0:0 offset1:1
  ds_read_b64 v[84:85], v61 offset:16
  ds_read2_b64 v[86:89], v61 offset0:96 offset1:97
  ds_read_b64 v[90:91], v61 offset:784
  s_waitcnt lgkmcnt(8)
  v_readlane_b32 s3, v6, 48
  v_max_f32 v108, v144, v144 quad_perm:[1,0,3,2] row_mask:0xf bank_mask:0xf
  s_cmp_eq_u32 s3, 7
  s_cbranch_scc0 L_fin
  v_max_f32 v108, v108, v108 quad_perm:[2,3,0,1] row_mask:0xf bank_mask:0xf
  s_nop 1
  v_max_f32 v108, v108, v108 row_half_mirror row_mask:0xf bank_mask:0xf
  v_sub_f32 v144, v144, v108
  v_mul_f32 v144, 0x3fb8aa3b, v144
  v_exp_f32 v144, v144
  s_nop 0
  v_mul_f32 v109, v144, v145
  v_mov_b32 v100, v144 row_newbcast:0 row_mask:0xf bank_mask:0xf
  v_mov_b32 v101, v144 row_newbcast:1 row_mask:0xf bank_mask:0xf
  v_add_f32 v109, v109, v109 quad_perm:[1,0,3,2] row_mask:0xf bank_mask:0xf
  v_mov_b32 v102, v144 row_newbcast:2 row_mask:0xf bank_mask:0xf
  v_mov_b32 v103, v144 row_newbcast:3 row_mask:0xf bank_mask:0xf
  v_add_f32 v109, v109, v109 quad_perm:[2,3,0,1] row_mask:0xf bank_mask:0xf
  s_waitcnt lgkmcnt(0)
  v_pk_mul_f32 v[68:69], v[68:69], v[100:101] op_sel:[0,0] op_sel_hi:[1,0]
  v_pk_mul_f32 v[70:71], v[70:71], v[100:101] op_sel:[0,0] op_sel_hi:[1,0]
  v_pk_mul_f32 v[72:73], v[72:73], v[100:101] op_sel:[0,0] op_sel_hi:[1,0]
  v_add_f32 v109, v109, v109 row_half_mirror row_mask:0xf bank_mask:0xf
  v_pk_fma_f32 v[68:69], v[74:75], v[100:101], v[68:69] op_sel:[0,1,0] op_sel_hi:[1,1,1]
  v_pk_fma_f32 v[70:71], v[76:77], v[100:101], v[70:71] op_sel:[0,1,0] op_sel_hi:[1,1,1]
  v_pk_fma_f32 v[72:73], v[78:79], v[100:101], v[72:73] op_sel:[0,1,0] op_sel_hi:[1,1,1]
  v_pk_fma_f32 v[68:69], v[80:81], v[102:103], v[68:69] op_sel:[0,0,0] op_sel_hi:[1,0,1]
  v_pk_fma_f32 v[70:71], v[82:83], v[102:103], v[70:71] op_sel:[0,0,0] op_sel_hi:[1,0,1]
  v_pk_fma_f32 v[72:73], v[84:85], v[102:103], v[72:73] op_sel:[0,0,0] op_sel_hi:[1,0,1]
  v_pk_fma_f32 v[68:69], v[86:87], v[102:103], v[68:69] op_sel:[0,1,0] op_sel_hi:[1,1,1]
  v_pk_fma_f32 v[70:71], v[88:89], v[102:103], v[70:71] op_sel:[0,1,0] op_sel_hi:[1,1,1]
  v_pk_fma_f32 v[72:73], v[90:91], v[102:103], v[72:73] op_sel:[0,1,0] op_sel_hi:[1,1,1]
  v_perm_b32 v110, v109, v108, v63
  v_permlane32_swap_b32 v68, v70
  v_permlane32_swap_b32 v69, v71
  v_permlane32_swap_b32 v72, v73
  v_or_b32 v110, v110, v64
  v_pk_add_f32 v[68:69], v[68:69], v[70:71]
  v_add_f32 v72, v72, v73
  v_cvt_pk_bf16_f32 v68, v68, v69
  v_cvt_pk_bf16_f32 v69, v72, v72
  v_bfi_b32 v69, v62, v69, v110
  buffer_store_dwordx2 v[68:69], v57, s[40:43], 0 offen sc1
  s_mov_b64 exec, 1
  ds_add_u32 v0, v1 offset:1028
  s_mov_b32 s12, 1
  s_atomic_add s12, s[52:53], 4 glc
  s_branch L_fin
L_ctrl:
L_rest:
  s_cmp_ge_u32 s10, 120
  s_cselect_b32 s12, 1, 0
  s_cselect_b32 s7, 40, 0
  s_sub_u32 s13, s10, 60
  s_sub_u32 s13, s13, s7
  s_lshl2_add_u32 s8, s12, s4
  s_branch L_rest2
L_cN:
  v_mov_b32 v0, 0
  v_lshlrev_b32 v75, 4, v2
  v_lshlrev_b32 v80, 2, v2
  v_mov_b32 v79, 1
  s_cmp_eq_u32 s4, 0
  s_cbranch_scc0 L_ci5
  ds_write_b32 v80, v0 offset:1024
L_ci5:
  s_waitcnt lgkmcnt(0)
  s_barrier
  s_load_dwordx2 s[14:15], s[40:41], 0
  s_getpc_b64 s[8:9]
L_pc1:
  s_sub_u32 s8, s8, L_pc1-L_base
  s_subb_u32 s9, s9, 0
  s_lshr_b32 s3, s2, 3
  s_lshl1_add_u32 s3, s3, s4
  s_and_b32 s3, s3, 15
  s_lshl_b32 s3, s3, 10
  v_add_u32 v76, s3, v75
  v_min_u32 v76, L_last-L_base-16, v76
  global_load_dwordx4 v[160:163], v76, s[8:9]
  s_waitcnt lgkmcnt(0)
  s_mul_i32 s14, s14, 0x9e3779b1
  s_add_u32 s14, s14, 0x7f4a7c15
  s_mul_i32 s15, s15, 0x85ebca6b
  s_add_u32 s15, s15, 0xc2b2ae35
  s_and_b32 s3, s14, 15
  s_sub_u32 s36, 0, s3
  s_subb_u32 s37, 0, s3
  s_mov_b64 exec, 1
  ds_add_u32 v0, v79 offset:1044
  s_mov_b64 exec, -1
  s_cmp_eq_u32 s4, 3
  s_cselect_b32 s3, s10, 64
  s_cmp_lt_u32 s3, 16
  s_cbranch_scc0 L_novote
  s_lshl_b32 s3, s10, 7
  s_add_u32 s3, s3, 1769472
  s_add_u32 s52, s40, s3
  s_addc_u32 s53, s41, 0
  s_load_dwordx2 s[54:55], s[0:1], 96
  s_load_dword s18, s[52:53], 0 glc
  s_load_dword s19, s[52:53], 8192 glc
  s_load_dword s20, s[52:53], 4096 glc
  s_load_dword s21, s[52:53], 12288 glc
  s_load_dword s22, s[52:53], 16384 glc
  s_load_dword s23, s[52:53], 24576 glc
  s_load_dword s26, s[52:53], 20480 glc
  s_load_dword s27, s[52:53], 28672 glc
  s_mov_b32 s8, 0
  s_waitcnt lgkmcnt(0)
  s_not_b32 s62, s18
  s_not_b32 s63, s19
  s_load_dword s62, s[52:53], 0 glc
  s_load_dword s63, s[52:53], 8192 glc
  s_waitcnt lgkmcnt(1)
  s_cmp_eq_u32 s62, s18
  s_addc_u32 s8, s8, 0
  s_cmp_lg_u32 s63, s19
  s_addc_u32 s8, s8, 0
  s_waitcnt lgkmcnt(0)
  s_not_b32 s62, s20
  s_not_b32 s63, s21
  s_load_dword s63, s[52:53], 12288 glc
  s_load_dword s62, s[52:53], 4096 glc
  s_waitcnt lgkmcnt(1)
  s_cmp_eq_u32 s62, s20
  s_addc_u32 s8, s8, 0
  s_cmp_lg_u32 s63, s21
  s_addc_u32 s8, s8, 0
  s_waitcnt lgkmcnt(0)
  s_not_b32 s62, s22
  s_not_b32 s63, s23
  s_load_dword s62, s[52:53], 16384 glc
  s_load_dword s63, s[52:53], 24576 glc
  s_waitcnt lgkmcnt(1)
  s_cmp_eq_u32 s62, s22
  s_addc_u32 s8, s8, 0
  s_cmp_lg_u32 s63, s23
  s_addc_u32 s8, s8, 0
  s_waitcnt lgkmcnt(0)
  s_not_b32 s62, s26
  s_not_b32 s63, s27
  s_load_dword s63, s[52:53], 28672 glc
  s_load_dword s62, s[52:53], 20480 glc
  s_waitcnt lgkmcnt(1)
  s_cmp_eq_u32 s62, s26
  s_addc_u32 s8, s8, 0
  s_cmp_lg_u32 s63, s27
  s_addc_u32 s8, s8, 0
  s_waitcnt lgkmcnt(0)
  s_sub_u32 s9, 8, s8
  s_bitcmp1_b32 s2, 2
  s_cselect_b32 s8, s8, s9
  s_add_u32 s8, s8, 0x10000
  s_atomic_add s8, s[54:55], 0 glc
  s_waitcnt lgkmcnt(0)
L_novote:
  s_waitcnt vmcnt(0)
  s_branch L_hopB
L_cA:
  v_mov_b32 v0, 0
  v_lshlrev_b32 v75, 4, v2
  v_lshlrev_b32 v80, 2, v2
  v_mov_b32 v79, 1
  s_cmp_eq_u32 s4, 0
  s_cbranch_scc0 L_ci6
  ds_write_b32 v80, v0 offset:1024
L_ci6:
  s_waitcnt lgkmcnt(0)
  s_barrier
  s_load_dwordx2 s[14:15], s[40:41], 0
  v_and_b32 v60, 1, v2
  v_lshlrev_b32 v60, 4, v60
  v_mov_b32 v61, 0xffff
  v_lshlrev_b32 v60, v60, v61
  v_bfe_u32 v61, v2, 1, 2
  v_cmp_eq_u32 vcc, 0, v61
  s_nop 1
  v_cndmask_b32 v4, 0, v60, vcc
  v_cmp_eq_u32 vcc, 1, v61
  s_nop 1
  v_cndmask_b32 v5, 0, v60, vcc
  v_cmp_eq_u32 vcc, 2, v61
  s_nop 1
  v_cndmask_b32 v6, 0, v60, vcc
  v_cmp_eq_u32 vcc, 3, v61
  s_nop 1
  v_cndmask_b32 v7, 0, v60, vcc
  s_mul_i32 s11, s12, 5120
  s_lshl_b32 s7, s13, 8
  s_add_u32 s11, s11, s7
  s_add_u32 s11, s11, 35840
  s_mov_b32 s54, 1
  s_cmp_lt_u32 s10, 80
  s_cbranch_scc1 L_cA1
  s_mul_i32 s11, s12, 15360
  s_add_u32 s11, s11, s7
  s_add_u32 s11, s11, 5120
  s_mov_b32 s54, 3
  s_setprio 0
  s_waitcnt vmcnt(0)
  s_call_b64 s[60:61], L_load10
L_cA1:
  s_waitcnt vmcnt(10)
  v_lshlrev_b32 v88, 16, v82
  v_and_b32 v89, 0xffff0000, v82
  v_mul_f32 v90, 0xbfb8aa3b, v88
  v_mul_f32 v91, 0xbfb8aa3b, v89
  v_exp_f32 v90, v90
  v_exp_f32 v91, v91
  s_lshl_b32 s3, s4, 9
  s_add_u32 s3, s3, 5120
  v_add_f32 v90, 1.0, v90
  v_add_f32 v91, 1.0, v91
  v_rcp_f32 v92, v90
  v_rcp_f32 v93, v91
  v_lshl_add_u32 v98, v2, 3, s3
  v_lshl_add_u32 v99, v3, 2, s3
  v_mul_f32 v94, v92, v88
  v_mul_f32 v95, v93, v89
  v_fma_f32 v96, -v94, v90, v88
  v_fma_f32 v97, -v95, v91, v89
  v_fmac_f32 v94, v96, v92
  v_fmac_f32 v95, v97, v93
  v_div_fixup_f32 v94, v94, v90, v88
  v_div_fixup_f32 v95, v95, v91, v89
  v_cvt_pk_bf16_f32 v94, v94, v94
  v_cvt_pk_bf16_f32 v95, v95, v95
  ds_write_b64 v98, v[94:95]
  ds_read2_b32 v[48:49], v99 offset0:0 offset1:8
  ds_read2_b32 v[50:51], v99 offset0:16 offset1:24
  ds_read2_b32 v[52:53], v99 offset0:32 offset1:40
  ds_read2_b32 v[54:55], v99 offset0:48 offset1:56
  ds_read2_b32 v[56:57], v99 offset0:64 offset1:72
  v_mov_b32 v60, 0
  v_mov_b32 v61, 0
  v_mov_b32 v62, 0
  v_mov_b32 v63, 0
  s_waitcnt lgkmcnt(0)
  s_mul_i32 s14, s14, 0x9e3779b1
  s_add_u32 s14, s14, 0x7f4a7c15
  s_mul_i32 s15, s15, 0x85ebca6b
  s_add_u32 s15, s15, 0xc2b2ae35
  s_and_b32 s3, s14, 15
  s_sub_u32 s36, 0, s3
  s_subb_u32 s37, 0, s3
  s_mov_b64 exec, 1
  ds_add_u32 v0, v79 offset:1044
  s_mov_b64 exec, -1
  s_waitcnt vmcnt(0)
  s_branch L_mm10
L_cB:
  v_mul_u32_u24 v72, 12288, v3
  s_mul_i32 s3, s4, 1966080
  s_mul_i32 s7, s5, 384
  s_add_u32 s3, s3, s7
  s_lshr_b32 s12, s2, 5
  s_lshl_b32 s7, s12, 7
  s_add_u32 s3, s3, s7
  v_add_u32 v72, v72, v1
  s_mov_b32 s46, 1966080
  s_mov_b32 s57, 98304
  v_mul_u32_u24 v73, 20, v2
  v_min_u32 v74, 39, v2
  s_mul_i32 s13, s4, 320
  v_lshl_add_u32 v74, v74, 3, s13
  v_mov_b32 v0, 0
  v_lshlrev_b32 v75, 4, v2
  v_lshlrev_b32 v80, 2, v2
  v_mov_b32 v79, 1
  s_cmp_eq_u32 s4, 0
  s_cbranch_scc0 L_ci7
  ds_write_b32 v80, v0 offset:1024
L_ci7:
  s_waitcnt lgkmcnt(0)
  s_load_dwordx2 s[14:15], s[40:41], 0
  s_add_u32 s44, s22, s3
  s_addc_u32 s45, s23, 0
  global_load_dwordx4 v[140:143], v73, s[16:17]
  global_load_dword v144, v73, s[16:17] offset:16
  global_load_dwordx2 v[146:147], v74, s[16:17]
  s_call_b64 s[60:61], L_load10
  s_mov_b32 s56, 983040
  buffer_load_dwordx4 v[88:91], v72, s[44:47], s56 offen nt
  s_add_u32 s56, s56, s57
  buffer_load_dwordx4 v[92:95], v72, s[44:47], s56 offen nt
  s_add_u32 s56, s56, s57
  buffer_load_dwordx4 v[96:99], v72, s[44:47], s56 offen nt
  s_add_u32 s56, s56, s57
  buffer_load_dwordx4 v[100:103], v72, s[44:47], s56 offen nt
  s_add_u32 s56, s56, s57
  buffer_load_dwordx4 v[104:107], v72, s[44:47], s56 offen nt
  s_add_u32 s56, s56, s57
  buffer_load_dwordx4 v[108:111], v72, s[44:47], s56 offen nt
  s_add_u32 s56, s56, s57
  buffer_load_dwordx4 v[112:115], v72, s[44:47], s56 offen nt
  s_add_u32 s56, s56, s57
  buffer_load_dwordx4 v[116:119], v72, s[44:47], s56 offen nt
  s_add_u32 s56, s56, s57
  buffer_load_dwordx4 v[120:123], v72, s[44:47], s56 offen nt
  s_add_u32 s56, s56, s57
  buffer_load_dwordx4 v[124:127], v72, s[44:47], s56 offen nt
  s_barrier
  s_or_b32 s3, s12, s4
  s_cbranch_scc1 L_notk
  s_mul_i32 s3, s5, 4352
  s_add_u32 s3, s3, 1572864
  v_mov_b32 v60, s3
  s_mov_b64 exec, 1
  v_mov_b32 v62, 0
  v_mov_b32 v63, 0
  buffer_store_dwordx2 v[62:63], v60, s[40:43], 0 offen sc1
  s_mov_b64 exec, -1
L_notk:
  v_and_b32 v64, 1, v2
  v_lshlrev_b32 v64, 4, v64
  v_mov_b32 v65, 0xffff
  v_lshlrev_b32 v64, v64, v65
  v_bfe_u32 v65, v2, 1, 2
  v_cmp_eq_u32 vcc, 0, v65
  s_nop 1
  v_cndmask_b32 v4, 0, v64, vcc
  v_cmp_eq_u32 vcc, 1, v65
  s_nop 1
  v_cndmask_b32 v5, 0, v64, vcc
  v_cmp_eq_u32 vcc, 2, v65
  s_nop 1
  v_cndmask_b32 v6, 0, v64, vcc
  v_cmp_eq_u32 vcc, 3, v65
  s_nop 1
  v_cndmask_b32 v7, 0, v64, vcc
  s_mul_i32 s11, s5, 768
  s_lshl_b32 s7, s12, 8
  s_add_u32 s11, s11, s7
  s_add_u32 s11, s11, 56320
  v_lshlrev_b32 v74, 1, v74
  s_mov_b32 s54, 3
  v_add_u32 v76, 35840, v74
  v_add_u32 v77, 40960, v74
  v_add_u32 v78, 46080, v74
  v_add_u32 v81, 51200, v74
  s_lshl_b32 s3, s13, 1
  s_add_u32 s3, s3, 11264
  v_lshl_add_u32 v73, v3, 2, s3
  s_waitcnt vmcnt(20) lgkmcnt(0)
  s_mul_i32 s14, s14, 0x9e3779b1
  s_add_u32 s14, s14, 0x7f4a7c15
  s_mul_i32 s15, s15, 0x85ebca6b
  s_add_u32 s15, s15, 0xc2b2ae35
  s_and_b32 s3, s14, 15
  s_sub_u32 s36, 0, s3
  s_subb_u32 s37, 0, s3
  s_mov_b64 exec, 1
  ds_add_u32 v0, v79 offset:1044
  s_mov_b64 exec, -1
  v_lshlrev_b32 v150, 16, v140
  v_and_b32 v151, 0xffff0000, v140
  v_lshlrev_b32 v152, 16, v141
  v_and_b32 v153, 0xffff0000, v141
  v_lshlrev_b32 v154, 16, v142
  v_and_b32 v155, 0xffff0000, v142
  v_lshlrev_b32 v156, 16, v143
  v_and_b32 v157, 0xffff0000, v143
  v_lshlrev_b32 v158, 16, v144
  v_and_b32 v159, 0xffff0000, v144
  v_lshlrev_b32 v160, 16, v146
  v_and_b32 v161, 0xffff0000, v146
  v_lshlrev_b32 v162, 16, v147
  v_and_b32 v163, 0xffff0000, v147
  v_add_f32 v60, v150, v151
  v_add_f32 v60, v60, v152
  v_add_f32 v60, v60, v153
  v_add_f32 v60, v60, v154
  v_add_f32 v60, v60, v155
  v_add_f32 v60, v60, v156
  v_add_f32 v60, v60, v157
  v_add_f32 v60, v60, v158
  v_add_f32 v60, v60, v159
  s_nop 1
  v_add_f32 v60, v60, v60 quad_perm:[1,0,3,2] row_mask:0xf bank_mask:0xf
  s_nop 1
  v_add_f32 v60, v60, v60 quad_perm:[2,3,0,1] row_mask:0xf bank_mask:0xf
  s_nop 1
  v_add_f32 v60, v60, v60 row_half_mirror row_mask:0xf bank_mask:0xf
  s_nop 1
  v_add_f32 v60, v60, v60 row_ror:8 row_mask:0xf bank_mask:0xf
  s_nop 1
  v_add_f32 v60, v60, v60 row_bcast:15 row_mask:0xa bank_mask:0xf
  s_nop 1
  v_add_f32 v60, v60, v60 row_bcast:31 row_mask:0xc bank_mask:0xf
  v_mul_f32 v60, 0x3acccccd, v60
  s_nop 0
  v_readlane_b32 s8, v60, 63
  s_nop 1
  v_subrev_f32 v150, s8, v150
  v_subrev_f32 v151, s8, v151
  v_subrev_f32 v152, s8, v152
  v_subrev_f32 v153, s8, v153
  v_subrev_f32 v154, s8, v154
  v_subrev_f32 v155, s8, v155
  v_subrev_f32 v156, s8, v156
  v_subrev_f32 v157, s8, v157
  v_subrev_f32 v158, s8, v158
  v_subrev_f32 v159, s8, v159
  v_mul_f32 v61, v150, v150
  v_fmac_f32 v61, v151, v151
  v_fmac_f32 v61, v152, v152
  v_fmac_f32 v61, v153, v153
  v_fmac_f32 v61, v154, v154
  v_fmac_f32 v61, v155, v155
  v_fmac_f32 v61, v156, v156
  v_fmac_f32 v61, v157, v157
  v_fmac_f32 v61, v158, v158
  v_fmac_f32 v61, v159, v159
  s_nop 1
  v_add_f32 v61, v61, v61 quad_perm:[1,0,3,2] row_mask:0xf bank_mask:0xf
  s_nop 1
  v_add_f32 v61, v61, v61 quad_perm:[2,3,0,1] row_mask:0xf bank_mask:0xf
  s_nop 1
  v_add_f32 v61, v61, v61 row_half_mirror row_mask:0xf bank_mask:0xf
  s_nop 1
  v_add_f32 v61, v61, v61 row_ror:8 row_mask:0xf bank_mask:0xf
  s_nop 1
  v_add_f32 v61, v61, v61 row_bcast:15 row_mask:0xa bank_mask:0xf
  s_nop 1
  v_add_f32 v61, v61, v61 row_bcast:31 row_mask:0xc bank_mask:0xf
  v_mul_f32 v61, 0x3acccccd, v61
  v_cvt_pk_bf16_f32 v62, v60, v61
  v_lshlrev_b32 v60, 16, v62
  v_and_b32 v61, 0xffff0000, v62
  v_add_f32 v61, 0x3727c5ac, v61
  v_cvt_pk_bf16_f32 v62, v61, v61
  v_lshlrev_b32 v61, 16, v62
  v_sqrt_f32 v61, v61
  s_nop 0
  v_cvt_pk_bf16_f32 v62, v61, v61
  v_lshlrev_b32 v61, 16, v62
  v_rcp_f32 v61, v61
  v_readlane_b32 s8, v60, 63
  v_readlane_b32 s9, v61, 63
  s_nop 0
  v_subrev_f32 v160, s8, v160
  v_subrev_f32 v161, s8, v161
  v_subrev_f32 v162, s8, v162
  v_subrev_f32 v163, s8, v163
  v_cvt_pk_bf16_f32 v62, v160, v161
  v_cvt_pk_bf16_f32 v63, v162, v163
  v_lshlrev_b32 v160, 16, v62
  v_and_b32 v161, 0xffff0000, v62
  v_lshlrev_b32 v162, 16, v63
  v_and_b32 v163, 0xffff0000, v63
  v_mul_f32 v160, s9, v160
  v_mul_f32 v161, s9, v161
  v_mul_f32 v162, s9, v162
  v_mul_f32 v163, s9, v163
  v_cvt_pk_bf16_f32 v62, v160, v161
  v_cvt_pk_bf16_f32 v63, v162, v163
  v_lshlrev_b32 v160, 16, v62
  v_and_b32 v161, 0xffff0000, v62
  v_lshlrev_b32 v162, 16, v63
  v_and_b32 v163, 0xffff0000, v63
  s_mov_b32 exec_lo, 0xffffffff
  s_mov_b32 exec_hi, 0xff
  s_waitcnt vmcnt(8)
  s_and_b32 s3, s14, 3
  s_sub_u32 s36, 0, s3
  s_subb_u32 s37, 0, s3
L_ha8:
  buffer_load_dwordx4 v[128:131], v76, s[40:43], 0 offen offset:0 sc1
  buffer_load_dwordx4 v[132:135], v77, s[40:43], 0 offen offset:0 sc1
  buffer_load_dwordx4 v[136:139], v78, s[40:43], 0 offen offset:0 sc1
  buffer_load_dwordx4 v[140:143], v81, s[40:43], 0 offen offset:0 sc1
  buffer_load_dwordx4 v[144:147], v76, s[40:43], 0 offen offset:2560 sc1
  buffer_load_dwordx4 v[148:151], v77, s[40:43], 0 offen offset:2560 sc1
  buffer_load_dwordx4 v[152:155], v78, s[40:43], 0 offen offset:2560 sc1
  buffer_load_dwordx4 v[156:159], v81, s[40:43], 0 offen offset:2560 sc1
  s_waitcnt vmcnt(0)
  v_lshl_add_u64 v[128:129], v[128:129], 0, s[36:37]
  v_lshl_add_u64 v[130:131], v[130:131], 0, s[36:37]
  v_lshl_add_u64 v[132:133], v[132:133], 0, s[36:37]
  v_lshl_add_u64 v[134:135], v[134:135], 0, s[36:37]
  v_lshl_add_u64 v[136:137], v[136:137], 0, s[36:37]
  v_lshl_add_u64 v[138:139], v[138:139], 0, s[36:37]
  v_lshl_add_u64 v[140:141], v[140:141], 0, s[36:37]
  v_lshl_add_u64 v[142:143], v[142:143], 0, s[36:37]
  v_lshl_add_u64 v[144:145], v[144:145], 0, s[36:37]
  v_lshl_add_u64 v[146:147], v[146:147], 0, s[36:37]
  v_lshl_add_u64 v[148:149], v[148:149], 0, s[36:37]
  v_lshl_add_u64 v[150:151], v[150:151], 0, s[36:37]
  v_lshl_add_u64 v[152:153], v[152:153], 0, s[36:37]
  v_lshl_add_u64 v[154:155], v[154:155], 0, s[36:37]
  v_lshl_add_u64 v[156:157], v[156:157], 0, s[36:37]
  v_lshl_add_u64 v[158:159], v[158:159], 0, s[36:37]
  v_or3_b32 v60, v128, v129, v130
  v_or3_b32 v60, v60, v131, v132
  v_or3_b32 v60, v60, v133, v134
  v_or3_b32 v60, v60, v135, v136
  v_or3_b32 v60, v60, v137, v138
  v_or3_b32 v60, v60, v139, v140
  v_or3_b32 v60, v60, v141, v142
  v_or3_b32 v60, v60, v143, v144
  v_or3_b32 v60, v60, v145, v146
  v_or3_b32 v60, v60, v147, v148
  v_or3_b32 v60, v60, v149, v150
  v_or3_b32 v60, v60, v151, v152
  v_or3_b32 v60, v60, v153, v154
  v_or3_b32 v60, v60, v155, v156
  v_or3_b32 v60, v60, v157, v158
  v_or_b32 v60, v60, v159
  v_and_b32 v60, 3, v60
  v_cmp_ne_u32 vcc, 0, v60
  s_cbranch_vccnz L_rt64
L_ok9:
  s_and_b32 s3, s14, 15
  s_sub_u32 s36, 0, s3
  s_subb_u32 s37, 0, s3
  v_pk_add_f32 v[128:129], v[128:129], v[132:133]
  v_pk_add_f32 v[130:131], v[130:131], v[134:135]
  v_pk_add_f32 v[144:145], v[144:145], v[148:149]
  v_pk_add_f32 v[146:147], v[146:147], v[150:151]
  v_pk_add_f32 v[136:137], v[136:137], v[140:141]
  v_pk_add_f32 v[138:139], v[138:139], v[142:143]
  v_pk_add_f32 v[152:153], v[152:153], v[156:157]
  v_pk_add_f32 v[154:155], v[154:155], v[158:159]
  v_pk_add_f32 v[128:129], v[128:129], v[136:137]
  v_pk_add_f32 v[130:131], v[130:131], v[138:139]
  v_pk_add_f32 v[144:145], v[144:145], v[152:153]
  v_pk_add_f32 v[146:147], v[146:147], v[154:155]
  v_cvt_pk_bf16_f32 v60, v144, v145
  v_cvt_pk_bf16_f32 v61, v146, v147
  v_cvt_pk_bf16_f32 v62, v128, v129
  v_cvt_pk_bf16_f32 v63, v130, v131
  v_lshlrev_b32 v144, 16, v60
  v_and_b32 v145, 0xffff0000, v60
  v_lshlrev_b32 v146, 16, v61
  v_and_b32 v147, 0xffff0000, v61
  v_lshlrev_b32 v128, 16, v62
  v_and_b32 v129, 0xffff0000, v62
  v_lshlrev_b32 v130, 16, v63
  v_and_b32 v131, 0xffff0000, v63
  v_add_f32 v144, 1.0, v144
  v_add_f32 v145, 1.0, v145
  v_add_f32 v146, 1.0, v146
  v_add_f32 v147, 1.0, v147
  v_cvt_pk_bf16_f32 v60, v144, v145
  v_cvt_pk_bf16_f32 v61, v146, v147
  v_lshlrev_b32 v144, 16, v60
  v_and_b32 v145, 0xffff0000, v60
  v_lshlrev_b32 v146, 16, v61
  v_and_b32 v147, 0xffff0000, v61
  v_mul_f32 v144, v144, v160
  v_mul_f32 v145, v145, v161
  v_mul_f32 v146, v146, v162
  v_mul_f32 v147, v147, v163
  v_cvt_pk_bf16_f32 v60, v144, v145
  v_cvt_pk_bf16_f32 v61, v146, v147
  v_lshlrev_b32 v144, 16, v60
  v_and_b32 v145, 0xffff0000, v60
  v_lshlrev_b32 v146, 16, v61
  v_and_b32 v147, 0xffff0000, v61
  v_add_f32 v144, v144, v128
  v_add_f32 v145, v145, v129
  v_add_f32 v146, v146, v130
  v_add_f32 v147, v147, v131
  v_cvt_pk_bf16_f32 v144, v144, v144
  v_cvt_pk_bf16_f32 v145, v145, v145
  v_cvt_pk_bf16_f32 v146, v146, v146
  v_cvt_pk_bf16_f32 v147, v147, v147
  ds_write_b128 v74, v[144:147] offset:11264
  s_mov_b64 exec, -1
  ds_read2_b32 v[128:129], v73 offset0:80 offset1:88
  ds_read2_b32 v[130:131], v73 offset0:96 offset1:104
  ds_read2_b32 v[132:133], v73 offset0:112 offset1:120
  ds_read2_b32 v[134:135], v73 offset0:128 offset1:136
  ds_read2_b32 v[136:137], v73 offset0:144 offset1:152
  ds_read2_b32 v[48:49], v73 offset0:0 offset1:8
  ds_read2_b32 v[50:51], v73 offset0:16 offset1:24
  ds_read2_b32 v[52:53], v73 offset0:32 offset1:40
  ds_read2_b32 v[54:55], v73 offset0:48 offset1:56
  ds_read2_b32 v[56:57], v73 offset0:64 offset1:72
  s_waitcnt lgkmcnt(0)
  v_and_b32 v64, v128, v4
  v_and_b32 v65, v128, v5
  v_and_b32 v66, v128, v6
  v_and_b32 v67, v128, v7
  s_nop 1
  v_mfma_f32_16x16x32_bf16 v[60:63], v[64:67], v[88:91], 0
  v_and_b32 v68, v129, v4
  v_and_b32 v69, v129, v5
  v_and_b32 v70, v129, v6
  v_and_b32 v71, v129, v7
  s_nop 1
  v_mfma_f32_16x16x32_bf16 v[60:63], v[68:71], v[92:95], v[60:63]
  v_and_b32 v64, v130, v4
  v_and_b32 v65, v130, v5
  v_and_b32 v66, v130, v6
  v_and_b32 v67, v130, v7
  s_nop 1
  v_mfma_f32_16x16x32_bf16 v[60:63], v[64:67], v[96:99], v[60:63]
  v_and_b32 v68, v131, v4
  v_and_b32 v69, v131, v5
  v_and_b32 v70, v131, v6
  v_and_b32 v71, v131, v7
  s_nop 1
  v_mfma_f32_16x16x32_bf16 v[60:63], v[68:71], v[100:103], v[60:63]
  v_and_b32 v64, v132, v4
  v_and_b32 v65, v132, v5
  v_and_b32 v66, v132, v6
  v_and_b32 v67, v132, v7
  s_nop 1
  v_mfma_f32_16x16x32_bf16 v[60:63], v[64:67], v[104:107], v[60:63]
  v_and_b32 v68, v133, v4
  v_and_b32 v69, v133, v5
  v_and_b32 v70, v133, v6
  v_and_b32 v71, v133, v7
  s_nop 1
  v_mfma_f32_16x16x32_bf16 v[60:63], v[68:71], v[108:111], v[60:63]
  v_and_b32 v64, v134, v4
  v_and_b32 v65, v134, v5
  v_and_b32 v66, v134, v6
  v_and_b32 v67, v134, v7
  s_nop 1
  v_mfma_f32_16x16x32_bf16 v[60:63], v[64:67], v[112:115], v[60:63]
  v_and_b32 v68, v135, v4
  v_and_b32 v69, v135, v5
  v_and_b32 v70, v135, v6
  v_and_b32 v71, v135, v7
  s_nop 1
  v_mfma_f32_16x16x32_bf16 v[60:63], v[68:71], v[116:119], v[60:63]
  v_and_b32 v64, v136, v4
  v_and_b32 v65, v136, v5
  v_and_b32 v66, v136, v6
  v_and_b32 v67, v136, v7
  s_nop 1
  v_mfma_f32_16x16x32_bf16 v[60:63], v[64:67], v[120:123], v[60:63]
  v_and_b32 v68, v137, v4
  v_and_b32 v69, v137, v5
  v_and_b32 v70, v137, v6
  v_and_b32 v71, v137, v7
  s_nop 1
  v_mfma_f32_16x16x32_bf16 v[60:63], v[68:71], v[124:127], v[60:63]
L_mm10:
  v_and_b32 v64, v48, v4
  v_and_b32 v65, v48, v5
  v_and_b32 v66, v48, v6
  v_and_b32 v67, v48, v7
  s_nop 1
  v_mfma_f32_16x16x32_bf16 v[60:63], v[64:67], v[8:11], v[60:63]
  v_and_b32 v68, v49, v4
  v_and_b32 v69, v49, v5
  v_and_b32 v70, v49, v6
  v_and_b32 v71, v49, v7
  s_nop 1
  v_mfma_f32_16x16x32_bf16 v[60:63], v[68:71], v[12:15], v[60:63]
  v_and_b32 v64, v50, v4
  v_and_b32 v65, v50, v5
  v_and_b32 v66, v50, v6
  v_and_b32 v67, v50, v7
  s_nop 1
  v_mfma_f32_16x16x32_bf16 v[60:63], v[64:67], v[16:19], v[60:63]
  v_and_b32 v68, v51, v4
  v_and_b32 v69, v51, v5
  v_and_b32 v70, v51, v6
  v_and_b32 v71, v51, v7
  s_nop 1
  v_mfma_f32_16x16x32_bf16 v[60:63], v[68:71], v[20:23], v[60:63]
  v_and_b32 v64, v52, v4
  v_and_b32 v65, v52, v5
  v_and_b32 v66, v52, v6
  v_and_b32 v67, v52, v7
  s_nop 1
  v_mfma_f32_16x16x32_bf16 v[60:63], v[64:67], v[24:27], v[60:63]
  v_and_b32 v68, v53, v4
  v_and_b32 v69, v53, v5
  v_and_b32 v70, v53, v6
  v_and_b32 v71, v53, v7
  s_nop 1
  v_mfma_f32_16x16x32_bf16 v[60:63], v[68:71], v[28:31], v[60:63]
  v_and_b32 v64, v54, v4
  v_and_b32 v65, v54, v5
  v_and_b32 v66, v54, v6
  v_and_b32 v67, v54, v7
  s_nop 1
  v_mfma_f32_16x16x32_bf16 v[60:63], v[64:67], v[32:35], v[60:63]
  v_and_b32 v68, v55, v4
  v_and_b32 v69, v55, v5
  v_and_b32 v70, v55, v6
  v_and_b32 v71, v55, v7
  s_nop 1
  v_mfma_f32_16x16x32_bf16 v[60:63], v[68:71], v[36:39], v[60:63]
  v_and_b32 v64, v56, v4
  v_and_b32 v65, v56, v5
  v_and_b32 v66, v56, v6
  v_and_b32 v67, v56, v7
  s_nop 1
  v_mfma_f32_16x16x32_bf16 v[60:63], v[64:67], v[40:43], v[60:63]
  v_and_b32 v68, v57, v4
  v_and_b32 v69, v57, v5
  v_and_b32 v70, v57, v6
  v_and_b32 v71, v57, v7
  s_nop 1
  v_mfma_f32_16x16x32_bf16 v[60:63], v[68:71], v[44:47], v[60:63]
  v_and_b32 v65, 16, v2
  v_lshrrev_b32 v66, 5, v2
  v_lshl_add_u32 v64, v1, 1, v65
  v_lshl_add_u32 v64, v66, 3, v64
  s_lshl_b32 s3, s4, 8
  v_add_u32 v64, s3, v64
  v_add_u32 v67, s11, v80
  s_and_b32 s9, s14, 0xffff
  v_permlane32_swap_b32 v60, v62
  v_permlane32_swap_b32 v61, v63
  s_nop 0
  v_add_f32 v60, v62, v60 row_ror:8 row_mask:0xf bank_mask:0xf
  v_add_f32 v61, v63, v61 row_ror:8 row_mask:0xf bank_mask:0xf
  s_mov_b32 exec_lo, 0xff00ff
  s_mov_b32 exec_hi, 0xff00ff
  ds_write_b64 v64, v[60:61] offset:2048
  s_mov_b64 exec, 1
  ds_add_rtn_u32 v66, v0, v79 offset:1060
  s_mov_b64 exec, -1
  ds_read2st64_b32 v[68:69], v80 offset0:8 offset1:9
  ds_read2st64_b32 v[70:71], v80 offset0:10 offset1:11
  s_waitcnt lgkmcnt(0)
  v_readfirstlane_b32 s3, v66
  s_cmp_eq_u32 s54, 1
  s_cselect_b32 s7, 3, 15
  v_mov_b32 v65, s7
  s_cbranch_scc1 L_two
  v_pk_add_f32 v[68:69], v[68:69], v[70:71]
L_two:
  v_add_f32 v68, v68, v69
  v_cvt_pk_bf16_f32 v69, v68, v68
  v_bfi_b32 v68, v65, s14, v68
  v_lshl_or_b32 v69, v69, 16, s9
  s_cmp_lt_u32 s2, 96
  s_cselect_b64 vcc, -1, 0
  v_cndmask_b32 v68, v68, v69, vcc
  s_cmp_eq_u32 s3, s54
  s_cbranch_scc0 L_nopub
  buffer_store_dword v68, v67, s[40:43], 0 offen sc1
L_nopub:
  s_setprio 3
L_hopB:
  s_cmp_eq_u32 s4, 1
  s_cbranch_scc0 L_tail
  s_mul_i32 s3, s5, 768
  s_add_u32 s3, s3, 56320
  v_add_u32 v73, s3, v75
  s_add_u32 s52, s40, s3
  s_addc_u32 s53, s41, 0
  v_mov_b32 v64, s14
  v_mov_b32 v65, s15
  ds_write_b64 v0, v[64:65] offset:1664
  v_mov_b32 v76, 0x07060302
  v_lshlrev_b32 v74, 3, v2
  s_load_dwordx2 s[54:55], s[0:1], 96
  s_lshl_b32 s7, s6, 4
  s_add_u32 s52, s52, s7
  s_addc_u32 s53, s53, 0
  s_mov_b32 exec_lo, 0xffffffff
  s_mov_b32 exec_hi, 0xffff
L_hb10:
  s_load_dword s62, s[52:53], 0 glc
  s_load_dword s63, s[52:53], 256 glc
  s_load_dword s64, s[52:53], 512 glc
  s_waitcnt lgkmcnt(0)
  s_xor_b32 s62, s62, s14
  s_xor_b32 s63, s63, s14
  s_xor_b32 s64, s64, s14
  s_or_b32 s62, s62, s63
  s_or_b32 s62, s62, s64
  s_and_b32 s62, s62, 0xffff
  s_cbranch_scc1 L_rt65
L_hbh11:
  buffer_load_dwordx4 v[84:87], v73, s[40:43], 0 offen sc1
  s_load_dword s8, s[54:55], 0
  s_branch L_vt13c
L_vt13:
  s_load_dword s8, s[54:55], 0 glc
L_vt13c:
  s_waitcnt lgkmcnt(0)
  s_lshr_b32 s3, s8, 16
  s_cmp_eq_u32 s3, 16
  s_cbranch_scc0 L_rt66
L_vtd14:
  s_and_b32 s8, s8, 0xffff
  s_cmp_gt_u32 s8, 64
  s_cselect_b32 s8, 8192, 0
  v_mov_b32 v66, s8
  ds_write_b32 v0, v66 offset:1672
  s_waitcnt vmcnt(0)
  v_bitop3_b32 v60, v84, v85, s14 bitop3:0x7e
  v_bitop3_b32 v61, v86, v87, s14 bitop3:0x7e
  v_or_b32 v60, v60, v61
  v_lshlrev_b32 v60, 16, v60
  v_cmp_ne_u32 vcc, 0, v60
  s_cbranch_vccnz L_rt67
L_hbd12:
  v_perm_b32 v84, v85, v84, v76
  v_perm_b32 v85, v87, v86, v76
  ds_write_b64 v74, v[84:85] offset:1280
  s_mov_b64 exec, 1
  ds_add_u32 v0, v79 offset:1044
  s_mov_b64 exec, -1
L_tail:
  v_lshrrev_b32 v4, 4, v2
  v_and_b32 v5, 15, v2
  v_lshrrev_b32 v6, 2, v5
  v_and_b32 v7, 3, v2
  v_lshlrev_b32 v7, 3, v7
  s_cmp_ge_u32 s2, 96
  s_cbranch_scc0 L_tailB
  s_lshr_b32 s13, s10, 3
  s_and_b32 s12, s2, 7
  s_lshl_b32 s12, s12, 1
  s_cmp_ge_u32 s13, 10
  s_cselect_b32 s3, 10, 0
  s_addc_u32 s12, s12, 0
  s_sub_u32 s13, s13, s3
  s_lshr_b32 s23, s10, 3
  s_lshr_b32 s3, s10, 5
  s_cmp_eq_u32 s4, 2
  s_cselect_b32 s7, 2, 0
  s_add_u32 s3, s3, s7
  s_and_b32 s7, s6, 3
  s_lshl2_add_u32 s3, s3, s7
  s_bfe_u32 s7, s10, 0x20003
  s_lshl2_add_u32 s9, s3, s7
  s_lshr_b32 s8, s6, 2
  s_mul_i32 s10, s8, 40
  s_add_u32 s10, s10, s9
  s_cmp_lt_u32 s9, 40
  s_cselect_b32 s57, 1, 0
  s_lshl_b32 s8, s8, 13
  s_lshl_b32 s9, s9, 5
  s_add_u32 s9, s9, s8
  s_sub_u32 s3, s4, 1
  s_cmp_lt_u32 s3, 2
  s_cselect_b32 s57, s57, 0
  s_cmp_ge_u32 s23, 8
  s_cselect_b32 s57, 2, s57
  s_mul_i32 s3, s6, 12
  s_add_u32 s23, s23, s3
  s_sub_u32 s23, s23, 8
  s_lshl2_add_u32 s3, s57, s4
  s_cmp_eq_u32 s3, 8
  s_cbranch_scc0 L_noxc
  s_getreg_b32 s3, hwreg(HW_REG_XCC_ID, 0, 4)
  s_andn2_b32 s7, s14, 15
  s_or_b32 s3, s3, s7
  v_mov_b32 v101, s3
  s_lshl_b32 s3, s23, 2
  v_mov_b32 v100, s3
  s_mov_b64 exec, 1
  buffer_store_dword v101, v100, s[40:43], 0 offen offset:512 sc1
  s_mov_b64 exec, -1
L_noxc:
  v_and_b32 v100, 1, v2
  v_lshl_add_u32 v100, v100, 2, v4
  s_lshl_b32 s3, s10, 3
  v_add_u32 v100, s3, v100
  v_lshlrev_b32 v101, 2, v100
  v_lshlrev_b32 v100, 1, v100
  v_add_u32 v102, 17920, v101
  v_add_u32 v101, 80896, v101
  v_bfe_u32 v103, v2, 1, 2
  v_lshlrev_b32 v103, 11, v103
  v_lshl_add_u32 v103, v3, 14, v103
  v_and_b32 v104, 1, v2
  v_lshl_add_u32 v103, v104, 4, v103
  s_add_u32 s3, s9, 524288
  v_add_u32 v103, s3, v103
  v_add_u32 v104, 131072, v103
  v_add_u32 v105, 262144, v103
  v_lshl_add_u32 v84, v4, 3, v6
  s_mul_i32 s3, s4, 96
  v_add_u32 v84, s3, v84
  v_lshl_add_u32 v84, v84, 7, v7
  v_lshl_add_u32 v85, v3, 9, v1
  s_lshr_b32 s3, s4, 1
  s_lshl1_add_u32 s8, s12, s3
  s_bfe_u32 s3, s8, 0x30001
  s_lshr_b32 s7, s8, 4
  s_lshl1_add_u32 s3, s3, s7
  s_and_b32 s7, s8, 1
  s_lshl1_add_u32 s3, s3, s7
  s_lshl_b32 s3, s3, 12
  s_add_u32 s3, s3, 98304
  s_and_b32 s7, s4, 1
  s_lshl_b32 s7, s7, 8
  s_add_u32 s3, s3, s7
  v_add_u32 v85, s3, v85
  v_mov_b32 v118, 0x05040100
  s_mul_i32 s3, s4, 2048
  s_add_u32 s3, s3, 60416
  v_and_b32 v90, 7, v2
  v_mul_u32_u24 v119, 192, v3
  v_mul_u32_u24 v91, 12, v90
  v_add3_u32 v119, v119, v91, s3
  v_mul_u32_u24 v133, 192, v90
  v_lshl_add_u32 v133, v4, 4, v133
  v_add_u32 v133, s3, v133
  v_lshl_add_u32 v134, v3, 4, v90
  v_add_u32 v134, s3, v134
  v_add_u32 v135, s3, v1
  v_cmp_gt_u32 vcc, 6, v90
  s_nop 1
  v_cndmask_b32 v90, 16, 24, vcc
  v_lshlrev_b32 v91, v90, s14
  v_lshlrev_b32 v128, v90, -1
  s_lshl_b32 s26, s14, 16
  v_lshrrev_b32 v86, 5, v2
  v_lshl_add_u32 v86, v86, 4, v5
  v_lshlrev_b32 v86, 5, v86
  v_and_b32 v87, 1, v4
  v_lshl_add_u32 v86, v87, 2, v86
  s_lshl_b32 s3, s4, 3
  v_add_u32 v86, s3, v86
  v_lshlrev_b32 v87, 5, v2
  s_lshr_b32 s3, s12, 1
  s_and_b32 s7, s12, 1
  s_lshl2_add_u32 s3, s3, s7
  s_lshl_b32 s3, s3, 12
  s_lshl_b32 s7, s13, 8
  s_add_u32 s3, s3, s7
  s_add_u32 s3, s3, 245760
  v_lshl_add_u32 v88, v2, 2, s3
  v_mov_b32 v89, 1
  v_mov_b32 v98, 0xffff0000
  s_mul_i32 s3, s12, 491520
  s_lshl_b32 s7, s13, 7
  s_add_u32 s3, s3, s7
  s_add_u32 s44, s24, s3
  s_addc_u32 s45, s25, 0
  s_mov_b32 s46, 491520
  v_mul_u32_u24 v72, 1280, v3
  v_and_b32 v90, 16, v2
  v_lshlrev_b32 v90, 1, v90
  v_xor_b32 v90, v90, v1
  v_add_u32 v72, v72, v90
  v_and_b32 v90, 1, v4
  v_lshrrev_b32 v92, 1, v6
  v_lshl_or_b32 v90, v90, 1, v92
  v_lshlrev_b32 v90, 5, v90
  v_add_u32 v84, v84, v90
  v_xor_b32 v154, 32, v84
  v_xor_b32 v155, 64, v84
  v_xor_b32 v156, 0x60, v84
  s_cmp_eq_u32 s4, 0
  s_cbranch_scc0 L_nodma
  s_movk_i32 s7, 11264
  s_setprio 1
  s_mov_b32 s56, 0
L_dmo16:
  s_mov_b32 s8, 0
L_dma15:
  s_mov_b32 m0, s7
  s_add_u32 s7, s7, 1024
  buffer_load_dwordx4 v72, s[44:47], s56 offen nt lds
  v_xor_b32 v72, 64, v72
  s_add_u32 s56, s56, 10240
  s_waitcnt vmcnt(3)
  s_add_u32 s8, s8, 1
  s_cmp_lt_u32 s8, 4
  s_cbranch_scc1 L_dma15
  s_add_u32 s7, s7, 8192
  s_add_u32 s56, s56, 81920
  s_cmp_lt_u32 s56, 491520
  s_cbranch_scc1 L_dmo16
  s_waitcnt vmcnt(0)
  ds_write_b32 v0, v89 offset:1036
L_nodma:
  s_setprio 3
L_w17:
  ds_read_b32 v90, v0 offset:1036
  s_waitcnt lgkmcnt(0)
  v_readfirstlane_b32 s3, v90
  s_cmp_ge_u32 s3, 1
  s_cbranch_scc0 L_rt68
L_d18:
  ds_read_b64_tr_b16 v[8:9], v84 offset:11264
  ds_read_b64_tr_b16 v[10:11], v84 offset:11776
  ds_read_b64_tr_b16 v[12:13], v154 offset:11264
  ds_read_b64_tr_b16 v[14:15], v154 offset:11776
  ds_read_b64_tr_b16 v[16:17], v155 offset:11264
  ds_read_b64_tr_b16 v[18:19], v155 offset:11776
  ds_read_b64_tr_b16 v[20:21], v156 offset:11264
  ds_read_b64_tr_b16 v[22:23], v156 offset:11776
  s_waitcnt lgkmcnt(0)
  s_cmp_eq_u32 s57, 1
  s_cbranch_scc0 L_nofin
  global_load_ushort v107, v100, s[38:39]
  v_add_u32 v132, 15360, v102
L_gb19:
  buffer_load_dword v120, v102, s[40:43], 0 offen sc1
  buffer_load_dword v121, v132, s[40:43], 0 offen sc1
  s_waitcnt vmcnt(0)
  v_lshl_add_u64 v[120:121], v[120:121], 0, s[36:37]
  v_or_b32 v90, v120, v121
  v_and_b32 v90, 15, v90
  v_cmp_ne_u32 vcc, 0, v90
  s_cbranch_vccnz L_rt69
L_ok20:
  v_add_f32 v106, v120, v121
  v_cvt_pk_bf16_f32 v90, v106, v106
  v_lshlrev_b32 v106, 16, v90
L_nofin:
  s_and_b32 s3, s14, 63
  s_sub_u32 s36, 0, s3
  s_subb_u32 s37, 0, s3
  v_add_u32 v90, 0, v2
  v_mul_u32_u24 v92, 3277, v90
  v_lshrrev_b32 v92, 16, v92
  v_mul_u32_u24 v92, 960, v92
  v_lshl_add_u32 v148, v90, 4, v92
  v_add_u32 v90, 64, v2
  v_mul_u32_u24 v92, 3277, v90
  v_lshrrev_b32 v92, 16, v92
  v_mul_u32_u24 v92, 960, v92
  v_lshl_add_u32 v149, v90, 4, v92
  v_add_u32 v90, 128, v2
  v_mul_u32_u24 v92, 3277, v90
  v_lshrrev_b32 v92, 16, v92
  v_mul_u32_u24 v92, 960, v92
  v_lshl_add_u32 v150, v90, 4, v92
  v_add_u32 v90, 192, v2
  v_mul_u32_u24 v92, 3277, v90
  v_lshrrev_b32 v92, 16, v92
  v_mul_u32_u24 v92, 960, v92
  v_lshl_add_u32 v151, v90, 4, v92
  v_add_u32 v90, 256, v2
  v_mul_u32_u24 v92, 3277, v90
  v_lshrrev_b32 v92, 16, v92
  v_mul_u32_u24 v92, 960, v92
  v_lshl_add_u32 v152, v90, 4, v92
  s_min_u32 s23, s23, 95
  s_mul_i32 s3, s23, 20480
  s_mul_i32 s7, s4, 320
  s_add_u32 s3, s3, s7
  s_add_u32 s48, s32, s3
  s_addc_u32 s49, s33, 0
  s_movk_i32 s50, 19520
  s_mul_i32 s13, s4, 5120
  s_add_u32 s13, s13, 68608
  s_lshr_b32 s3, s23, 2
  s_lshr_b32 s7, s4, 1
  s_lshl1_add_u32 s3, s3, s7
  s_and_b32 s7, s23, 3
  s_lshl2_add_u32 s3, s3, s7
  s_lshl_b32 s3, s3, 11
  s_and_b32 s7, s4, 1
  s_mul_i32 s7, s7, 640
  s_add_u32 s12, s3, s7
  s_add_u32 s12, s12, 524288
  v_lshl_add_u32 v153, v2, 7, s12
  v_and_b32 v132, 1, v4
  v_lshl_add_u32 v132, v132, 3, v6
  v_mul_u32_u24 v132, 320, v132
  v_lshrrev_b32 v90, 1, v4
  v_lshl_add_u32 v90, v90, 5, v7
  v_add3_u32 v132, v132, v90, s13
  v_and_b32 v165, 16, v2
  v_lshl_add_u32 v165, v165, 3, v1
  v_lshrrev_b32 v90, 5, v2
  v_mul_u32_u24 v90, 384, v90
  v_add_u32 v165, v165, v90
  v_cmp_eq_u32 vcc, 8, v2
  v_mov_b32 v90, 256
  s_nop 0
  v_cndmask_b32 v165, v165, v90, vcc
  s_mul_i32 s3, s23, 2560
  s_add_u32 s3, s3, 933888
  v_add_u32 v165, s3, v165
  v_lshlrev_b32 v166, 6, v5
  v_lshl_add_u32 v166, v4, 4, v166
  v_add_u32 v166, s12, v166
  v_lshrrev_b32 v90, 1, v4
  v_and_b32 v92, 1, v2
  v_cmp_eq_u32 s[62:63], v90, v92
  v_lshrrev_b32 v90, 1, v5
  v_cmp_eq_u32 vcc, 0, v90
  s_and_b64 vcc, vcc, s[62:63]
  s_nop 0
  v_cndmask_b32 v160, 0, -1, vcc
  v_cmp_eq_u32 vcc, 1, v90
  s_and_b64 vcc, vcc, s[62:63]
  s_nop 0
  v_cndmask_b32 v161, 0, -1, vcc
  v_cmp_eq_u32 vcc, 2, v90
  s_and_b64 vcc, vcc, s[62:63]
  s_nop 0
  v_cndmask_b32 v162, 0, -1, vcc
  v_cmp_eq_u32 vcc, 3, v90
  s_and_b64 vcc, vcc, s[62:63]
  s_nop 0
  v_cndmask_b32 v163, 0, -1, vcc
  v_cmp_eq_u32 vcc, 4, v90
  s_and_b64 vcc, vcc, s[62:63]
  s_nop 0
  v_cndmask_b32 v164, 0, -1, vcc
L_w21:
  ds_read_b32 v90, v0 offset:1044
  s_waitcnt lgkmcnt(0)
  v_readfirstlane_b32 s3, v90
  s_cmp_ge_u32 s3, 5
  s_cbranch_scc0 L_rt70
L_d22:
  ds_read_b32 v90, v0 offset:1672
  s_waitcnt lgkmcnt(0)
  v_readfirstlane_b32 s27, v90
  s_nop 1
  v_xor_b32 v85, s27, v85
  v_xor_b32 v103, s27, v103
  v_xor_b32 v104, s27, v104
  v_xor_b32 v105, s27, v105
  v_xor_b32 v153, s27, v153
  v_xor_b32 v166, s27, v166
  s_cmp_eq_u32 s4, 2
  s_cbranch_scc0 L_nowarm
  s_bfe_u32 s3, s5, 0x30001
  s_lshr_b32 s8, s5, 4
  s_lshl1_add_u32 s3, s3, s8
  s_and_b32 s8, s5, 1
  s_lshl1_add_u32 s3, s3, s8
  s_lshl_b32 s3, s3, 12
  s_add_u32 s3, s3, 98304
  s_lshl_b32 s8, s6, 9
  s_add_u32 s3, s3, s8
  s_xor_b32 s3, s3, s27
  v_lshl_add_u32 v90, v2, 7, s3
  s_mov_b64 exec, 15
  buffer_load_dword v167, v90, s[40:43], 0 offen sc1
  s_mov_b32 exec_lo, 0x1
  s_mov_b32 exec_hi, 0x1
  buffer_load_dword v167, v88, s[40:43], 0 offen sc1
  s_mov_b64 exec, -1
L_nowarm:
  s_mul_i32 s7, s4, 12288
  s_add_u32 s7, s7, 15360
  s_mul_i32 s56, s4, 122880
  s_add_u32 s56, s56, 40960
  s_mov_b32 s16, 131072
  s_mov_b32 s17, 8192
  s_mov_b32 s18, 139264
L_w23:
  ds_read_b32 v90, v0 offset:1024
  s_waitcnt lgkmcnt(0)
  v_readfirstlane_b32 s3, v90
  s_cmp_ge_u32 s3, 1
  s_cbranch_scc0 L_rt71
L_d24:
L_w25:
  ds_read_b32 v90, v0 offset:1024
  s_waitcnt lgkmcnt(0)
  v_readfirstlane_b32 s3, v90
  s_cmp_ge_u32 s3, 4
  s_cbranch_scc0 L_rt72
L_d26:
  s_mov_b32 m0, s7
  s_add_u32 s7, s7, 1024
  buffer_load_dwordx4 v72, s[44:47], s56 offen nt lds
  v_xor_b32 v72, 64, v72
  s_add_u32 s56, s56, 10240
  s_mov_b32 m0, s7
  s_add_u32 s7, s7, 1024
  buffer_load_dwordx4 v72, s[44:47], s56 offen nt lds
  v_xor_b32 v72, 64, v72
  s_add_u32 s56, s56, 10240
  s_mov_b32 m0, s7
  s_add_u32 s7, s7, 1024
  buffer_load_dwordx4 v72, s[44:47], s56 offen nt lds
  v_xor_b32 v72, 64, v72
  s_add_u32 s56, s56, 10240
  s_mov_b32 m0, s7
  s_add_u32 s7, s7, 1024
  buffer_load_dwordx4 v72, s[44:47], s56 offen nt lds
  v_xor_b32 v72, 64, v72
  s_add_u32 s56, s56, 10240
  s_mov_b32 m0, s7
  s_add_u32 s7, s7, 1024
  buffer_load_dwordx4 v72, s[44:47], s56 offen nt lds
  v_xor_b32 v72, 64, v72
  s_add_u32 s56, s56, 10240
  s_mov_b32 m0, s7
  s_add_u32 s7, s7, 1024
  buffer_load_dwordx4 v72, s[44:47], s56 offen nt lds
  v_xor_b32 v72, 64, v72
  s_add_u32 s56, s56, 10240
  s_mov_b32 m0, s7
  s_add_u32 s7, s7, 1024
  buffer_load_dwordx4 v72, s[44:47], s56 offen nt lds
  v_xor_b32 v72, 64, v72
  s_add_u32 s56, s56, 10240
  s_mov_b32 m0, s7
  s_add_u32 s7, s7, 1024
  buffer_load_dwordx4 v72, s[44:47], s56 offen nt lds
  v_xor_b32 v72, 64, v72
  s_add_u32 s56, s56, 10240
  s_waitcnt vmcnt(4) lgkmcnt(0)
  ds_read_b64_tr_b16 v[24:25], v84 offset:15360
  ds_read_b64_tr_b16 v[26:27], v84 offset:15872
  ds_read_b64_tr_b16 v[28:29], v154 offset:15360
  ds_read_b64_tr_b16 v[30:31], v154 offset:15872
  ds_read_b64_tr_b16 v[32:33], v155 offset:15360
  ds_read_b64_tr_b16 v[34:35], v155 offset:15872
  ds_read_b64_tr_b16 v[36:37], v156 offset:15360
  ds_read_b64_tr_b16 v[38:39], v156 offset:15872
  s_waitcnt vmcnt(0) lgkmcnt(0)
  ds_read_b64_tr_b16 v[40:41], v84 offset:19456
  ds_read_b64_tr_b16 v[42:43], v84 offset:19968
  ds_read_b64_tr_b16 v[44:45], v154 offset:19456
  ds_read_b64_tr_b16 v[46:47], v154 offset:19968
  ds_read_b64_tr_b16 v[48:49], v155 offset:19456
  ds_read_b64_tr_b16 v[50:51], v155 offset:19968
  ds_read_b64_tr_b16 v[52:53], v156 offset:19456
  ds_read_b64_tr_b16 v[54:55], v156 offset:19968
L_w27:
  ds_read_b32 v90, v0 offset:1028
  s_waitcnt lgkmcnt(0)
  v_readfirstlane_b32 s3, v90
  s_cmp_ge_u32 s3, 9
  s_cbranch_scc0 L_rt73
L_d28:
L_wp30:
  buffer_load_dwordx4 v[120:123], v85, s[40:43], 0 offen offset:0 sc1
  buffer_load_dwordx4 v[124:127], v85, s[40:43], 0 offen offset:128 sc1
L_wochk:
  s_waitcnt vmcnt(1)
  v_perm_b32 v136, v123, v121, v118
  ds_write2_b32 v119, v120, v122 offset0:0 offset1:1
  ds_write_b8_d16_hi v134, v123 offset:1538
  ds_write_b32 v119, v136 offset:8
  v_bitop3_b32 v92, v123, v91, v128 bitop3:0x28
  v_xor_b32 v93, s26, v121
  s_waitcnt vmcnt(0)
  v_perm_b32 v137, v127, v125, v118
  ds_write2_b32 v119, v124, v126 offset0:24 offset1:25
  ds_write_b32 v119, v137 offset:104
  s_mov_b64 s[8:9], exec
  s_mov_b64 exec, -1
  ds_read_b64 v[142:143], v135 offset:1536
  ds_read_b128 v[56:59], v133 offset:0
  ds_read_b128 v[60:63], v133 offset:64
  ds_read_b128 v[64:67], v133 offset:128
  s_mov_b64 exec, s[8:9]
  v_bitop3_b32 v94, v125, v127, s26 bitop3:0x7e
  v_bitop3_b32 v93, v93, v94, v98 bitop3:0xa8
  v_or_b32 v90, v92, v93
  v_cmp_ne_u32 vcc, 0, v90
  s_wqm_b64 exec, vcc
  s_cbranch_scc1 L_rt74
L_woq31:
  s_mov_b64 exec, -1
  s_waitcnt lgkmcnt(0)
  v_and_b32 v142, v98, v142
  v_mfma_f32_16x16x32_bf16 v[68:71], v[56:59], v[8:11], 0
  s_nop 0
  v_max_f32 v116, v142, v142 quad_perm:[1,0,3,2] row_mask:0xf bank_mask:0xf
  v_mfma_f32_16x16x32_bf16 v[72:75], v[56:59], v[12:15], 0
  s_nop 0
  v_max_f32 v116, v116, v116 quad_perm:[2,3,0,1] row_mask:0xf bank_mask:0xf
  v_mfma_f32_16x16x32_bf16 v[76:79], v[56:59], v[16:19], 0
  s_nop 0
  v_max_f32 v116, v116, v116 row_half_mirror row_mask:0xf bank_mask:0xf
  v_sub_f32 v116, v142, v116
  v_mfma_f32_16x16x32_bf16 v[80:83], v[56:59], v[20:23], 0
  v_mul_f32 v116, 0x3fb8aa3b, v116
  v_exp_f32 v116, v116
  v_mfma_f32_16x16x32_bf16 v[68:71], v[60:63], v[24:27], v[68:71]
  v_mul_f32 v117, v116, v143
  v_mfma_f32_16x16x32_bf16 v[72:75], v[60:63], v[28:31], v[72:75]
  s_nop 0
  v_add_f32 v117, v117, v117 quad_perm:[1,0,3,2] row_mask:0xf bank_mask:0xf
  v_mfma_f32_16x16x32_bf16 v[76:79], v[60:63], v[32:35], v[76:79]
  s_nop 0
  v_add_f32 v117, v117, v117 quad_perm:[2,3,0,1] row_mask:0xf bank_mask:0xf
  v_mfma_f32_16x16x32_bf16 v[80:83], v[60:63], v[36:39], v[80:83]
  s_nop 0
  v_add_f32 v117, v117, v117 row_half_mirror row_mask:0xf bank_mask:0xf
  v_rcp_f32 v117, v117
  v_mfma_f32_16x16x32_bf16 v[68:71], v[64:67], v[40:43], v[68:71]
  v_mul_f32 v116, v116, v117
  v_mfma_f32_16x16x32_bf16 v[72:75], v[64:67], v[44:47], v[72:75]
  s_nop 0
  v_mov_b32 v112, v116 row_newbcast:0 row_mask:0x5 bank_mask:0xf
  v_mov_b32 v113, v116 row_newbcast:1 row_mask:0x5 bank_mask:0xf
  v_mfma_f32_16x16x32_bf16 v[76:79], v[64:67], v[48:51], v[76:79]
  v_mov_b32 v114, v116 row_newbcast:2 row_mask:0x5 bank_mask:0xf
  v_mov_b32 v115, v116 row_newbcast:3 row_mask:0x5 bank_mask:0xf
  v_mfma_f32_16x16x32_bf16 v[80:83], v[64:67], v[52:55], v[80:83]
  v_mov_b32 v112, v116 row_newbcast:4 row_mask:0xa bank_mask:0xf
  v_mov_b32 v113, v116 row_newbcast:5 row_mask:0xa bank_mask:0xf
  v_mov_b32 v114, v116 row_newbcast:6 row_mask:0xa bank_mask:0xf
  v_mov_b32 v115, v116 row_newbcast:7 row_mask:0xa bank_mask:0xf
  s_mov_b32 exec_lo, 0
  v_pk_mul_f32 v[144:145], v[72:73], v[112:113]
  v_pk_fma_f32 v[144:145], v[74:75], v[114:115], v[144:145]
  s_nop 0
  v_pk_mul_f32 v[146:147], v[80:81], v[112:113]
  v_pk_fma_f32 v[146:147], v[82:83], v[114:115], v[146:147]
  s_not_b64 exec, exec
  v_pk_mul_f32 v[144:145], v[68:69], v[112:113]
  v_pk_fma_f32 v[144:145], v[70:71], v[114:115], v[144:145]
  v_pk_mul_f32 v[146:147], v[76:77], v[112:113]
  v_pk_fma_f32 v[146:147], v[78:79], v[114:115], v[146:147]
  s_mov_b64 exec, -1
  v_add_f32 v68, v144, v145
  v_add_f32 v76, v146, v147
  ds_write_b32 v86, v68 offset:3072
  ds_write_b32 v86, v76 offset:4096
  s_mov_b64 exec, 1
  ds_add_rtn_u32 v90, v0, v89 offset:1040
  s_mov_b64 exec, -1
  ds_read_b128 v[92:95], v87 offset:3072
  ds_read_b128 v[96:99], v87 offset:3088
  s_waitcnt lgkmcnt(0)
  v_readfirstlane_b32 s3, v90
  v_pk_add_f32 v[92:93], v[92:93], v[94:95]
  v_pk_add_f32 v[96:97], v[96:97], v[98:99]
  v_pk_add_f32 v[92:93], v[92:93], v[96:97]
  v_add_f32 v92, v92, v93
  v_bfi_b32 v92, 63, s14, v92
  s_cmp_eq_u32 s3, 3
  s_cbranch_scc0 L_wonost
  buffer_store_dword v92, v88, s[40:43], 0 offen sc1
  buffer_store_dword v92, v88, s[40:43], s16 offen sc1
  buffer_store_dword v92, v88, s[40:43], s17 offen sc1
  buffer_store_dword v92, v88, s[40:43], s18 offen sc1
L_wonost:
  s_cmp_eq_u32 s57, 2
  s_cbranch_scc1 L_act
  s_cmp_eq_u32 s57, 0
  s_cbranch_scc1 L_fin
L_fx32:
  buffer_load_dword v20, v101, s[40:43], 0 offen sc1
  s_waitcnt vmcnt(0)
  v_xor_b32 v21, s14, v20
  v_lshlrev_b32 v21, 16, v21
  v_cmp_ne_u32 vcc, 0, v21
  s_cbranch_vccnz L_rt75
L_fxd33:
  s_mov_b64 exec, 1
L_fg34:
  buffer_load_dwordx4 v[8:11], v104, s[40:43], 0 offen sc1
  s_waitcnt vmcnt(0)
  v_bitop3_b32 v90, v8, v9, s14 bitop3:0x7e
  v_bitop3_b32 v91, v10, v11, s14 bitop3:0x7e
  v_bitop3_b32 v90, v90, v91, 63 bitop3:0xa8
  v_cmp_eq_u32 vcc, 0, v90
  s_cbranch_vccz L_rt76
L_fgd35:
  s_mov_b64 exec, -1
L_fi36:
  buffer_load_dwordx4 v[8:11], v103, s[40:43], 0 offen sc1
  buffer_load_dwordx4 v[12:15], v104, s[40:43], 0 offen sc1
  buffer_load_dwordx4 v[16:19], v105, s[40:43], 0 offen sc1
  s_waitcnt vmcnt(1)
  v_lshl_add_u64 v[8:9], v[8:9], 0, s[36:37]
  v_lshl_add_u64 v[10:11], v[10:11], 0, s[36:37]
  v_lshl_add_u64 v[12:13], v[12:13], 0, s[36:37]
  v_lshl_add_u64 v[14:15], v[14:15], 0, s[36:37]
  v_pk_add_f32 v[22:23], v[8:9], v[12:13]
  v_pk_add_f32 v[24:25], v[10:11], v[14:15]
  v_or3_b32 v90, v8, v9, v10
  v_or3_b32 v91, v11, v12, v13
  s_waitcnt vmcnt(0)
  v_lshl_add_u64 v[16:17], v[16:17], 0, s[36:37]
  v_lshl_add_u64 v[18:19], v[18:19], 0, s[36:37]
  v_pk_add_f32 v[22:23], v[22:23], v[16:17]
  v_pk_add_f32 v[24:25], v[24:25], v[18:19]
  v_or3_b32 v90, v90, v14, v15
  v_or3_b32 v91, v91, v16, v17
  v_permlane32_swap_b32 v22, v24
  v_permlane32_swap_b32 v23, v25
  v_pk_add_f32 v[22:23], v[22:23], v[24:25]
  v_or3_b32 v90, v90, v18, v19
  v_bitop3_b32 v90, v90, v91, 63 bitop3:0xa8
  v_permlane16_swap_b32 v22, v23
  v_add_f32 v26, v22, v23
  v_cmp_ne_u32 vcc, 0, v90
  s_cbranch_vccnz L_rt77
L_fid37:
  v_add_f32 v26, v26, v26 row_ror:2 row_mask:0xf bank_mask:0xf
  s_nop 1
  v_add_f32 v26, v26, v26 row_ror:4 row_mask:0xf bank_mask:0xf
  v_and_b32 v20, 0xffff0000, v20
  s_nop 0
  v_add_f32 v26, v26, v26 row_ror:8 row_mask:0xf bank_mask:0xf
  v_cvt_pk_bf16_f32 v26, v26, v26
  v_and_b32 v26, 0xffff0000, v26
  v_mul_f32 v26, v26, v106
  v_cvt_pk_bf16_f32 v26, v26, v26
  v_and_b32 v26, 0xffff0000, v26
  v_add_f32 v26, v26, v20
  v_cvt_pk_bf16_f32 v26, v26, v26
  s_mov_b32 exec_lo, 0x30003
  s_mov_b32 exec_hi, 0x30003
  global_store_short v100, v26, s[38:39]
  s_endpgm
L_tailB:
  s_setprio 3
L_w38:
  ds_read_b32 v90, v0 offset:1044
  s_waitcnt lgkmcnt(0)
  v_readfirstlane_b32 s3, v90
  s_cmp_ge_u32 s3, 5
  s_cbranch_scc0 L_rt78
L_d39:
  ds_read_b32 v90, v0 offset:1672
  s_waitcnt lgkmcnt(0)
  v_readfirstlane_b32 s27, v90
  s_and_b32 s3, s2, 7
  s_mul_i32 s3, s3, 3
  s_lshr_b32 s7, s2, 5
  s_add_u32 s3, s3, s7
  s_lshl_b32 s3, s3, 2
  s_bfe_u32 s7, s2, 0x20003
  s_add_u32 s12, s3, s7
  s_and_b32 s57, s12, 3
  s_mul_i32 s13, s57, 160
  s_mul_i32 s3, s4, 40
  v_lshl_add_u32 v80, v5, 2, s3
  v_add_u32 v81, v80, v4
  v_lshlrev_b32 v85, 1, v81
  v_add_u32 v81, s13, v81
  v_lshlrev_b32 v82, 1, v81
  v_lshlrev_b32 v86, 2, v81
  v_add_u32 v80, s13, v80
  s_add_u32 s44, s40, 10240
  s_addc_u32 s45, s41, 0
  s_mov_b32 s46, 30720
  s_movk_i32 s20, 5120
  s_movk_i32 s21, 15360
  s_movk_i32 s22, 20480
  v_lshrrev_b32 v84, 1, v4
  v_lshlrev_b32 v84, 14, v84
  v_and_b32 v90, 1, v4
  v_lshl_add_u32 v84, v90, 12, v84
  v_lshl_add_u32 v84, v80, 2, v84
  s_bfe_u32 s3, s6, 0x10001
  s_lshl_b32 s3, s3, 4
  s_lshr_b32 s7, s6, 2
  s_add_u32 s3, s3, s7
  s_lshl_b32 s3, s3, 13
  s_xor_b32 s3, s3, s27
  s_add_u32 s3, s3, 245760
  s_add_u32 s48, s40, s3
  s_addc_u32 s49, s41, 0
  s_mov_b32 s50, 122880
  s_mov_b32 exec_lo, 0x3ff03ff
  s_mov_b32 exec_hi, 0x3ff03ff
  global_load_ushort v71, v82, s[16:17]
  s_andn2_b32 s3, s12, 3
  s_add_u32 s3, s3, s4
  s_lshl_b32 s3, s3, 2
  v_mov_b32 v112, s3
L_mf40:
  buffer_load_dword v108, v112, s[40:43], 0 offen offset:512 sc1
  buffer_load_dword v100, v86, s[44:47], 0 offen offset:0 sc1
  buffer_load_dword v101, v86, s[44:47], s21 offen offset:0 sc1
  buffer_load_dword v102, v86, s[44:47], 0 offen offset:2560 sc1
  buffer_load_dword v103, v86, s[44:47], s21 offen offset:2560 sc1
  buffer_load_dword v104, v86, s[44:47], s20 offen offset:0 sc1
  buffer_load_dword v105, v86, s[44:47], s22 offen offset:0 sc1
  s_waitcnt vmcnt(0)
  v_lshl_add_u64 v[100:101], v[100:101], 0, s[36:37]
  v_lshl_add_u64 v[102:103], v[102:103], 0, s[36:37]
  v_lshl_add_u64 v[104:105], v[104:105], 0, s[36:37]
  v_or3_b32 v90, v100, v101, v102
  v_or3_b32 v90, v90, v103, v104
  v_or_b32 v90, v90, v105
  v_xor_b32 v113, s14, v108
  v_and_b32 v113, -16, v113
  v_min_u32 v113, 1, v113
  v_or_b32 v90, v90, v113
  v_and_b32 v90, 15, v90
  v_cmp_ne_u32 vcc, 0, v90
  s_cbranch_vccnz L_rt79
L_ok41:
  v_readfirstlane_b32 s16, v108
  s_getreg_b32 s3, hwreg(HW_REG_XCC_ID, 0, 4)
  s_xor_b32 s16, s16, s3
  s_and_b32 s16, s16, 15
  v_add_f32 v68, v100, v101
  v_add_f32 v69, v102, v103
  v_add_f32 v70, v104, v105
  v_cvt_pk_bf16_f32 v90, v68, v69
  v_cvt_pk_bf16_f32 v91, v70, v70
  v_lshlrev_b32 v68, 16, v90
  v_and_b32 v69, 0xffff0000, v90
  v_lshlrev_b32 v70, 16, v91
  v_lshlrev_b32 v71, 16, v71
  v_add_f32 v70, 1.0, v70
  v_cvt_pk_bf16_f32 v90, v70, v70
  v_lshlrev_b32 v70, 16, v90
  v_mov_b32 v90, 1.0
  ds_write_b16_d16_hi v85, v70 offset:3072
  ds_write_b16_d16_hi v85, v69 offset:3408
  ds_write_b16_d16_hi v85, v90 offset:4752
  s_mov_b64 exec, -1
  v_add_u32 v86, 80896, v86
  v_mul_u32_u24 v72, 3072, v3
  v_and_b32 v73, 16, v2
  v_lshlrev_b32 v73, 1, v73
  v_and_b32 v73, 32, v73
  s_and_b32 s3, s4, 1
  s_lshl_b32 s3, s3, 6
  v_or_b32 v73, s3, v73
  v_xor_b32 v73, v73, v1
  v_add_u32 v72, v72, v73
  s_lshr_b32 s3, s12, 2
  s_lshl_b32 s3, s3, 7
  s_lshl_b32 s7, s57, 2
  s_add_u32 s7, s7, s4
  s_mul_i32 s7, s7, 122880
  s_add_u32 s3, s3, s7
  s_add_u32 s44, s28, s3
  s_addc_u32 s45, s29, 0
  s_mov_b32 s46, 122880
  s_add_u32 s52, s30, s3
  s_addc_u32 s53, s31, 0
  s_mov_b32 s54, 122880
  s_mov_b32 s55, 0x20000
  s_mul_i32 s11, s4, 5120
  s_add_u32 s7, s11, 11264
  v_lshl_add_u32 v87, v4, 3, v6
  v_lshl_add_u32 v87, v87, 7, v7
  v_and_b32 v88, 1, v4
  v_lshrrev_b32 v89, 1, v6
  v_lshl_or_b32 v89, v88, 1, v89
  v_and_b32 v89, 3, v89
  v_xor_b32 v89, s4, v89
  v_lshl_add_u32 v87, v89, 5, v87
  v_mov_b32 v79, 1
  s_cmp_eq_u32 s4, 2
  s_cbranch_scc0 L_nowarmB
  s_bfe_u32 s3, s5, 0x30001
  s_lshr_b32 s8, s5, 4
  s_lshl1_add_u32 s3, s3, s8
  s_and_b32 s8, s5, 1
  s_lshl1_add_u32 s3, s3, s8
  s_lshl_b32 s3, s3, 12
  s_add_u32 s3, s3, 98304
  s_lshl_b32 s8, s6, 9
  s_add_u32 s3, s3, s8
  s_xor_b32 s3, s3, s27
  v_lshl_add_u32 v90, v2, 7, s3
  s_mov_b64 exec, 15
  buffer_load_dword v167, v90, s[40:43], 0 offen sc1
  s_mov_b64 exec, -1
L_nowarmB:
  v_min_u32 v76, 5, v5
  v_mul_u32_u24 v76, 336, v76
  v_lshl_add_u32 v76, v4, 4, v76
  s_andn2_b32 s3, s12, 3
  s_add_u32 s3, s3, s4
  s_lshl_b32 s3, s3, 2
  s_add_u32 s3, s3, s57
  s_mul_i32 s3, s3, 640
  s_add_u32 s3, s3, 933888
  v_min_u32 v77, 16, v2
  v_lshl_add_u32 v77, v77, 4, s3
  s_mov_b32 s20, 32768
  s_mov_b32 s21, 65536
  s_mov_b32 s22, 98304
  v_cmp_eq_u32 s[34:35], 20, v2
  s_mov_b32 s18, 0x03ff03ff
  s_mov_b32 s19, 0x03ff03ff
  s_and_b32 s17, s14, 0xffff
  s_and_b32 s3, s14, 63
  s_sub_u32 s36, 0, s3
  s_subb_u32 s37, 0, s3
  s_mov_b32 s56, 0
L_w42:
  ds_read_b32 v90, v0 offset:1024
  s_waitcnt lgkmcnt(0)
  v_readfirstlane_b32 s3, v90
  s_cmp_ge_u32 s3, 1
  s_cbranch_scc0 L_rt80
L_d43:
L_w44:
  ds_read_b32 v90, v0 offset:1024
  s_waitcnt lgkmcnt(0)
  v_readfirstlane_b32 s3, v90
  s_cmp_ge_u32 s3, 8
  s_cbranch_scc0 L_rt81
L_d45:
  s_mov_b32 m0, s7
  s_add_u32 s3, s7, 20480
  buffer_load_dwordx4 v72, s[44:47], s56 offen nt lds
  s_mov_b32 m0, s3
  s_add_u32 s7, s7, 1024
  buffer_load_dwordx4 v72, s[52:55], s56 offen nt lds
  v_xor_b32 v72, 64, v72
  s_add_u32 s56, s56, 24576
L_w46:
  ds_read_b32 v90, v0 offset:1028
  s_waitcnt lgkmcnt(0)
  v_readfirstlane_b32 s3, v90
  s_cmp_ge_u32 s3, 9
  s_cbranch_scc0 L_rt82
L_d47:
  s_cmp_eq_u32 s4, 0
  s_cbranch_scc0 L_bgw50
  s_mul_i32 s8, s5, 4352
  s_add_u32 s8, s8, 1572868
L_bg48:
  s_load_dword s3, s[40:41], s8 glc
  s_waitcnt lgkmcnt(0)
  s_cmp_ge_u32 s3, 5
  s_cbranch_scc0 L_rt83
L_bgd49:
  ds_write_b32 v0, v79 offset:1032
L_bgw50:
L_w51:
  ds_read_b32 v90, v0 offset:1032
  s_waitcnt lgkmcnt(0)
  v_readfirstlane_b32 s3, v90
  s_cmp_ge_u32 s3, 1
  s_cbranch_scc0 L_rt84
L_d52:
  s_mov_b32 m0, s7
  s_add_u32 s3, s7, 20480
  buffer_load_dwordx4 v72, s[44:47], s56 offen nt lds
  s_mov_b32 m0, s3
  s_add_u32 s7, s7, 1024
  buffer_load_dwordx4 v72, s[52:55], s56 offen nt lds
  v_xor_b32 v72, 64, v72
  s_add_u32 s56, s56, 24576
  s_mov_b32 m0, s7
  s_add_u32 s3, s7, 20480
  buffer_load_dwordx4 v72, s[44:47], s56 offen nt lds
  s_mov_b32 m0, s3
  s_add_u32 s7, s7, 1024
  buffer_load_dwordx4 v72, s[52:55], s56 offen nt lds
  v_xor_b32 v72, 64, v72
  s_add_u32 s56, s56, 24576
  s_mov_b32 m0, s7
  s_add_u32 s3, s7, 20480
  buffer_load_dwordx4 v72, s[44:47], s56 offen nt lds
  s_mov_b32 m0, s3
  s_add_u32 s7, s7, 1024
  buffer_load_dwordx4 v72, s[52:55], s56 offen nt lds
  v_xor_b32 v72, 64, v72
  s_add_u32 s56, s56, 24576
  s_mov_b32 m0, s7
  s_add_u32 s3, s7, 20480
  buffer_load_dwordx4 v72, s[44:47], s56 offen nt lds
  s_mov_b32 m0, s3
  s_add_u32 s7, s7, 1024
  buffer_load_dwordx4 v72, s[52:55], s56 offen nt lds
  s_waitcnt vmcnt(0)
  s_mov_b64 exec, s[18:19]
  buffer_load_dwordx4 v[100:103], v84, s[48:51], 0 offen sc1
  buffer_load_dwordx4 v[104:107], v84, s[48:51], s20 offen sc1
  buffer_load_dwordx4 v[108:111], v84, s[48:51], s21 offen sc1
  buffer_load_dwordx4 v[112:115], v84, s[48:51], s22 offen sc1
  s_waitcnt vmcnt(4)
  s_mov_b64 exec, 1
  ds_add_u32 v0, v79 offset:1036
  s_mov_b64 exec, -1
L_w53:
  ds_read_b32 v90, v0 offset:1036
  s_waitcnt lgkmcnt(0)
  v_readfirstlane_b32 s3, v90
  s_cmp_ge_u32 s3, 4
  s_cbranch_scc0 L_rt85
L_d54:
  ds_read_b64_tr_b16 v[8:9], v87 offset:11264
  ds_read_b64_tr_b16 v[28:29], v87 offset:31744
  ds_read_b64_tr_b16 v[10:11], v87 offset:11776
  ds_read_b64_tr_b16 v[30:31], v87 offset:32256
  ds_read_b64_tr_b16 v[12:13], v87 offset:15360
  ds_read_b64_tr_b16 v[32:33], v87 offset:35840
  ds_read_b64_tr_b16 v[14:15], v87 offset:15872
  ds_read_b64_tr_b16 v[34:35], v87 offset:36352
  ds_read_b64_tr_b16 v[16:17], v87 offset:19456
  ds_read_b64_tr_b16 v[36:37], v87 offset:39936
  ds_read_b64_tr_b16 v[18:19], v87 offset:19968
  ds_read_b64_tr_b16 v[38:39], v87 offset:40448
  ds_read_b64_tr_b16 v[20:21], v87 offset:23552
  ds_read_b64_tr_b16 v[40:41], v87 offset:44032
  ds_read_b64_tr_b16 v[22:23], v87 offset:24064
  ds_read_b64_tr_b16 v[42:43], v87 offset:44544
  ds_read_b64_tr_b16 v[24:25], v87 offset:27648
  ds_read_b64_tr_b16 v[44:45], v87 offset:48128
  ds_read_b64_tr_b16 v[26:27], v87 offset:28160
  ds_read_b64_tr_b16 v[46:47], v87 offset:48640
  s_mov_b64 exec, s[18:19]
  s_branch L_pchk
L_pp55:
  buffer_load_dwordx4 v[100:103], v84, s[48:51], 0 offen sc1
  buffer_load_dwordx4 v[104:107], v84, s[48:51], s20 offen sc1
  buffer_load_dwordx4 v[108:111], v84, s[48:51], s21 offen sc1
  buffer_load_dwordx4 v[112:115], v84, s[48:51], s22 offen sc1
L_pchk:
  s_waitcnt vmcnt(2)
  v_lshl_add_u64 v[100:101], v[100:101], 0, s[36:37]
  v_lshl_add_u64 v[102:103], v[102:103], 0, s[36:37]
  v_lshl_add_u64 v[104:105], v[104:105], 0, s[36:37]
  v_lshl_add_u64 v[106:107], v[106:107], 0, s[36:37]
  v_pk_add_f32 v[96:97], v[100:101], v[104:105]
  v_pk_add_f32 v[98:99], v[102:103], v[106:107]
  v_or3_b32 v90, v100, v101, v102
  v_or3_b32 v91, v103, v104, v105
  v_or3_b32 v90, v90, v106, v107
  s_waitcnt vmcnt(1)
  v_lshl_add_u64 v[108:109], v[108:109], 0, s[36:37]
  v_lshl_add_u64 v[110:111], v[110:111], 0, s[36:37]
  v_pk_add_f32 v[96:97], v[96:97], v[108:109]
  v_pk_add_f32 v[98:99], v[98:99], v[110:111]
  v_or3_b32 v91, v91, v108, v109
  v_or3_b32 v90, v90, v110, v111
  s_waitcnt vmcnt(0)
  v_lshl_add_u64 v[112:113], v[112:113], 0, s[36:37]
  v_lshl_add_u64 v[114:115], v[114:115], 0, s[36:37]
  v_pk_add_f32 v[96:97], v[96:97], v[112:113]
  v_pk_add_f32 v[98:99], v[98:99], v[114:115]
  v_or3_b32 v91, v91, v112, v113
  v_or3_b32 v90, v90, v114, v115
  v_permlane32_swap_b32 v96, v98
  v_permlane32_swap_b32 v97, v99
  v_pk_add_f32 v[96:97], v[96:97], v[98:99]
  v_bitop3_b32 v90, v90, v91, 63 bitop3:0xa8
  v_cmp_ne_u32 vcc, 0, v90
  v_permlane16_swap_b32 v96, v97
  v_add_f32 v96, v96, v97
  v_cvt_pk_bf16_f32 v96, v96, v96
  s_cbranch_vccnz L_rt86
L_ppd56:
  v_and_b32 v96, 0xffff0000, v96
  v_mul_f32 v96, v96, v68
  v_cvt_pk_bf16_f32 v96, v96, v96
  v_and_b32 v96, 0xffff0000, v96
  v_add_f32 v96, v96, v71
  v_cvt_pk_bf16_f32 v96, v96, v96
  v_and_b32 v96, 0xffff0000, v96
  v_mul_f32 v97, v96, v70
  ds_write_b16_d16_hi v85, v96 offset:4416
  v_and_b32 v98, 0xffff0000, v97
  ds_write_b16_d16_hi v85, v97 offset:3744
  v_sub_f32 v98, v97, v98
  ds_write_b16_d16_hi v85, v98 offset:4080
  s_mov_b64 exec, 1
  ds_add_u32 v0, v79 offset:1052
  s_mov_b64 exec, -1
L_h257:
  ds_read_b32 v90, v0 offset:1052
  ds_read_b128 v[100:103], v76 offset:3072
  ds_read_b128 v[104:107], v76 offset:3136
  ds_read_b128 v[108:111], v76 offset:3200
  ds_read_b128 v[112:115], v76 offset:3264
  ds_read_b128 v[116:119], v76 offset:3328
L_h2w:
  s_waitcnt lgkmcnt(0)
  v_cmp_gt_u32 vcc, 4, v90
  s_cbranch_vccnz L_rt87
L_h2d58:
  v_mfma_f32_16x16x32_bf16 v[128:131], v[100:103], v[100:103], 0
  v_mfma_f32_16x16x32_bf16 v[120:123], v[100:103], v[8:11], 0
  v_mfma_f32_16x16x32_bf16 v[128:131], v[104:107], v[104:107], v[128:131]
  v_mfma_f32_16x16x32_bf16 v[120:123], v[104:107], v[12:15], v[120:123]
  v_mfma_f32_16x16x32_bf16 v[128:131], v[108:111], v[108:111], v[128:131]
  v_mfma_f32_16x16x32_bf16 v[120:123], v[108:111], v[16:19], v[120:123]
  v_mfma_f32_16x16x32_bf16 v[128:131], v[112:115], v[112:115], v[128:131]
  v_mfma_f32_16x16x32_bf16 v[120:123], v[112:115], v[20:23], v[120:123]
  v_mfma_f32_16x16x32_bf16 v[128:131], v[116:119], v[116:119], v[128:131]
  v_mfma_f32_16x16x32_bf16 v[120:123], v[116:119], v[24:27], v[120:123]
  v_mfma_f32_16x16x32_bf16 v[124:127], v[100:103], v[28:31], 0
  v_mfma_f32_16x16x32_bf16 v[124:127], v[104:107], v[32:35], v[124:127]
  v_mfma_f32_16x16x32_bf16 v[124:127], v[108:111], v[36:39], v[124:127]
  v_mfma_f32_16x16x32_bf16 v[124:127], v[112:115], v[40:43], v[124:127]
  v_mfma_f32_16x16x32_bf16 v[124:127], v[116:119], v[44:47], v[124:127]
  v_or_b32 v96, s17, v96
  s_cmp_eq_u32 s16, 0
  s_mov_b64 exec, 0x10ffff
  v_add_f32 v122, v122, v123
  v_mov_b32 v123, s14
  v_cndmask_b32 v120, v120, v128, s[34:35]
  v_cndmask_b32 v121, v121, v129, s[34:35]
  s_cbranch_scc0 L_guslow
  buffer_store_dwordx4 v[120:123], v77, s[40:43], 0 offen
  v_add_f32 v126, v126, v127
  v_mov_b32 v127, s14
  s_mov_b64 exec, 0xffff
  buffer_store_dwordx4 v[124:127], v77, s[40:43], 0 offen offset:384
L_gust:
  s_lshl2_add_u32 s3, s12, s4
  s_cmp_eq_u32 s3, 32
  s_cbranch_scc0 L_noep
  s_mov_b64 exec, 1
  v_mov_b32 v90, s14
  v_mov_b32 v91, s15
  buffer_store_dwordx2 v[90:91], v0, s[40:43], 0 offen offset:0 sc1
L_noep:
  s_cmp_lt_u32 s12, 4
  s_cbranch_scc0 L_fin
  s_mov_b64 exec, s[18:19]
  buffer_store_dword v96, v86, s[40:43], 0 offen sc1
  s_branch L_fin
L_guslow:
  buffer_store_dwordx4 v[120:123], v77, s[40:43], 0 offen sc1
  v_add_f32 v126, v126, v127
  v_mov_b32 v127, s14
  s_mov_b64 exec, 0xffff
  buffer_store_dwordx4 v[124:127], v77, s[40:43], 0 offen offset:384 sc1
  s_branch L_gust
L_act:
L_w59:
  ds_read_b32 v90, v0 offset:1040
  s_waitcnt lgkmcnt(0)
  v_readfirstlane_b32 s3, v90
  s_cmp_ge_u32 s3, 4
  s_cbranch_scc0 L_rt88
L_d60:
  s_add_u32 m0, s13, 0
  s_nop 0
  buffer_load_dwordx4 v148, s[48:51], 0 offen nt lds
  s_add_u32 m0, s13, 1024
  s_nop 0
  buffer_load_dwordx4 v149, s[48:51], 0 offen nt lds
  s_add_u32 m0, s13, 2048
  s_nop 0
  buffer_load_dwordx4 v150, s[48:51], 0 offen nt lds
  s_add_u32 m0, s13, 3072
  s_nop 0
  buffer_load_dwordx4 v151, s[48:51], 0 offen nt lds
  s_add_u32 m0, s13, 4096
  s_nop 0
  buffer_load_dwordx4 v152, s[48:51], 0 offen nt lds
  s_mov_b64 exec, 31
  buffer_load_dword v167, v153, s[40:43], 0 offen sc1
  s_lshl2_add_u32 s3, s23, s4
  s_mul_i32 s3, s3, 640
  s_add_u32 s3, s3, 933888
  v_lshl_add_u32 v153, v2, 7, s3
  buffer_load_dword v167, v153, s[40:43], 0 offen sc1
  s_mov_b64 exec, -1
  s_mov_b32 s38, 0xff01ff
  s_mov_b32 s39, 0xff00ff
  s_lshl_b32 s11, s14, 2
  v_mov_b32 v93, 0x3acccccd
  s_mov_b64 exec, s[38:39]
  buffer_load_dwordx4 v[100:103], v165, s[40:43], 0 offen offset:0 sc1
  buffer_load_dwordx4 v[104:107], v165, s[40:43], 0 offen offset:640 sc1
  buffer_load_dwordx4 v[108:111], v165, s[40:43], 0 offen offset:1280 sc1
  buffer_load_dwordx4 v[112:115], v165, s[40:43], 0 offen offset:1920 sc1
  s_mov_b64 exec, -1
  s_waitcnt vmcnt(4)
  ds_read_b64_tr_b16 v[48:49], v132 offset:0
  ds_read_b64_tr_b16 v[50:51], v132 offset:1280
  ds_read_b64_tr_b16 v[52:53], v132 offset:64
  ds_read_b64_tr_b16 v[54:55], v132 offset:1344
  ds_read_b64_tr_b16 v[56:57], v132 offset:128
  ds_read_b64_tr_b16 v[58:59], v132 offset:1408
  ds_read_b64_tr_b16 v[60:61], v132 offset:192
  ds_read_b64_tr_b16 v[62:63], v132 offset:1472
  ds_read_b64_tr_b16 v[64:65], v132 offset:256
  ds_read_b64_tr_b16 v[66:67], v132 offset:1536
  s_mov_b64 exec, s[38:39]
  s_branch L_guw
L_gu61:
  buffer_load_dwordx4 v[100:103], v165, s[40:43], 0 offen offset:0 sc1
  buffer_load_dwordx4 v[104:107], v165, s[40:43], 0 offen offset:640 sc1
  buffer_load_dwordx4 v[108:111], v165, s[40:43], 0 offen offset:1280 sc1
  buffer_load_dwordx4 v[112:115], v165, s[40:43], 0 offen offset:1920 sc1
L_guw:
  s_waitcnt vmcnt(0)
  v_pk_add_f32 v[140:141], v[100:101], v[104:105]
  v_pk_add_f32 v[142:143], v[108:109], v[112:113]
  v_add3_u32 v90, v103, v107, v111
  v_pk_add_f32 v[140:141], v[140:141], v[142:143]
  v_add_u32 v90, v90, v115
  v_readlane_b32 s8, v140, 8
  v_readlane_b32 s9, v141, 8
  v_cmp_ne_u32 vcc, s11, v90
  s_cbranch_vccnz L_rt89
L_gud62:
  v_mul_f32 v94, s9, v93
  v_mul_f32 v95, s8, v93
  v_add_f32 v148, v102, v106
  v_fma_f32 v95, -v94, v94, v95
  v_add_f32 v149, v110, v114
  v_max_f32 v95, 0, v95
  v_cvt_pk_bf16_f32 v90, v94, v95
  v_add_f32 v148, v148, v149
  v_and_b32 v95, 0xffff0000, v90
  v_lshlrev_b32 v94, 16, v90
  v_add_f32 v95, 0x3727c5ac, v95
  v_cvt_pk_bf16_f32 v95, v95, v95
  v_fma_f32 v148, -v94, v140, v148
  v_and_b32 v95, 0xffff0000, v95
  v_sqrt_f32 v95, v95
  s_nop 0
  v_cvt_pk_bf16_f32 v95, v95, v95
  v_and_b32 v95, 0xffff0000, v95
  v_rcp_f32 v95, v95
  s_mov_b64 exec, -1
  v_fma_f32 v152, v148, v95, v141
  v_cvt_pk_bf16_f32 v152, v152, v152
  v_and_b32 v154, 0xffff0000, v152
  v_and_b32 v152, 0xffff0000, v152
  v_mov_b32 v155, 0xc0135761
  s_nop 0
  v_permlane32_swap_b32 v152, v154
  v_mul_f32 v153, v152, v152
  v_fmac_f32 v155, 0xbdd2d3e8, v153
  v_mul_f32 v155, v155, v152
  v_exp_f32 v155, v155
  s_nop 0
  v_add_f32 v155, 1.0, v155
  v_rcp_f32 v155, v155
  s_nop 0
  v_mul_f32 v152, v152, v155
  v_cvt_pk_bf16_f32 v152, v152, v152
  v_and_b32 v152, 0xffff0000, v152
  v_mul_f32 v152, v152, v154
  s_waitcnt lgkmcnt(0)
  s_nop 0
  v_mov_b32 v153, v152 quad_perm:[1,0,3,2] row_mask:0xf bank_mask:0xf
  v_cvt_pk_bf16_f32 v152, v152, v153
  s_nop 1
  v_and_b32 v8, v152, v160 row_newbcast:0 row_mask:0xf bank_mask:0xf
  v_and_b32 v9, v152, v160 row_newbcast:2 row_mask:0xf bank_mask:0xf
  v_and_b32 v10, v152, v160 row_newbcast:4 row_mask:0xf bank_mask:0xf
  v_and_b32 v11, v152, v160 row_newbcast:6 row_mask:0xf bank_mask:0xf
  v_and_b32 v12, v152, v161 row_newbcast:0 row_mask:0xf bank_mask:0xf
  v_and_b32 v13, v152, v161 row_newbcast:2 row_mask:0xf bank_mask:0xf
  v_and_b32 v14, v152, v161 row_newbcast:4 row_mask:0xf bank_mask:0xf
  v_and_b32 v15, v152, v161 row_newbcast:6 row_mask:0xf bank_mask:0xf
  v_mfma_f32_16x16x32_bf16 v[156:159], v[48:51], v[8:11], 0
  v_and_b32 v16, v152, v162 row_newbcast:0 row_mask:0xf bank_mask:0xf
  v_and_b32 v17, v152, v162 row_newbcast:2 row_mask:0xf bank_mask:0xf
  v_and_b32 v18, v152, v162 row_newbcast:4 row_mask:0xf bank_mask:0xf
  v_and_b32 v19, v152, v162 row_newbcast:6 row_mask:0xf bank_mask:0xf
  v_mfma_f32_16x16x32_bf16 v[156:159], v[52:55], v[12:15], v[156:159]
  v_and_b32 v20, v152, v163 row_newbcast:0 row_mask:0xf bank_mask:0xf
  v_and_b32 v21, v152, v163 row_newbcast:2 row_mask:0xf bank_mask:0xf
  v_and_b32 v22, v152, v163 row_newbcast:4 row_mask:0xf bank_mask:0xf
  v_and_b32 v23, v152, v163 row_newbcast:6 row_mask:0xf bank_mask:0xf
  v_mfma_f32_16x16x32_bf16 v[156:159], v[56:59], v[16:19], v[156:159]
  v_and_b32 v24, v152, v164 row_newbcast:0 row_mask:0xf bank_mask:0xf
  v_and_b32 v25, v152, v164 row_newbcast:2 row_mask:0xf bank_mask:0xf
  v_and_b32 v26, v152, v164 row_newbcast:4 row_mask:0xf bank_mask:0xf
  v_and_b32 v27, v152, v164 row_newbcast:6 row_mask:0xf bank_mask:0xf
  v_mfma_f32_16x16x32_bf16 v[156:159], v[60:63], v[20:23], v[156:159]
  s_nop 0
  v_mfma_f32_16x16x32_bf16 v[156:159], v[64:67], v[24:27], v[156:159]
  s_mov_b32 exec_lo, 0x3ff03ff
  s_mov_b32 exec_hi, 0x3ff03ff
  s_nop 5
  v_bfi_b32 v156, 63, s14, v156
  v_bfi_b32 v157, 63, s14, v157
  v_bfi_b32 v158, 63, s14, v158
  v_bfi_b32 v159, 63, s14, v159
  buffer_store_dwordx4 v[156:159], v166, s[40:43], 0 offen sc1
L_fin:
L_end:
  s_endpgm
L_rt63:
  s_sleep 2
  s_sub_u32 s58, s58, 1
  s_cbranch_scc0 L_w1
  s_branch L_fin
L_rt64:
  s_sleep 8
  s_sub_u32 s58, s58, 1
  s_cbranch_scc0 L_ha8
  s_branch L_fin
L_rt65:
  s_sleep 4
  s_sub_u32 s58, s58, 1
  s_cbranch_scc0 L_hb10
  s_branch L_fin
L_rt66:
  s_sleep 16
  s_sub_u32 s58, s58, 1
  s_cbranch_scc0 L_vt13
  s_branch L_fin
L_rt67:
  s_sleep 4
  s_sub_u32 s58, s58, 1
  s_cbranch_scc0 L_hb10
  s_branch L_fin
L_rt68:
  s_sleep 8
  s_sub_u32 s58, s58, 1
  s_cbranch_scc0 L_w17
  s_branch L_fin
L_rt69:
  s_sleep 16
  s_sub_u32 s58, s58, 1
  s_cbranch_scc0 L_gb19
  s_branch L_fin
L_rt70:
  s_sleep 8
  s_sub_u32 s58, s58, 1
  s_cbranch_scc0 L_w21
  s_branch L_fin
L_rt71:
  s_sleep 16
  s_sub_u32 s58, s58, 1
  s_cbranch_scc0 L_w23
  s_branch L_fin
L_rt72:
  s_sleep 1
  s_sub_u32 s58, s58, 1
  s_cbranch_scc0 L_w25
  s_branch L_fin
L_rt73:
  s_sub_u32 s58, s58, 1
  s_cbranch_scc0 L_w27
  s_branch L_fin
L_rt74:
  s_sleep 1
  s_sub_u32 s58, s58, 1
  s_cbranch_scc0 L_wp30
  s_branch L_fin
L_rt75:
  s_sleep 1
  s_sub_u32 s58, s58, 1
  s_cbranch_scc0 L_fx32
  s_branch L_fin
L_rt76:
  s_sub_u32 s58, s58, 1
  s_cbranch_scc0 L_fg34
  s_branch L_fin
L_rt77:
  s_sub_u32 s58, s58, 1
  s_cbranch_scc0 L_fi36
  s_branch L_fin
L_rt78:
  s_sleep 8
  s_sub_u32 s58, s58, 1
  s_cbranch_scc0 L_w38
  s_branch L_fin
L_rt79:
  s_sleep 16
  s_sub_u32 s58, s58, 1
  s_cbranch_scc0 L_mf40
  s_branch L_fin
L_rt80:
  s_sleep 16
  s_sub_u32 s58, s58, 1
  s_cbranch_scc0 L_w42
  s_branch L_fin
L_rt81:
  s_sleep 1
  s_sub_u32 s58, s58, 1
  s_cbranch_scc0 L_w44
  s_branch L_fin
L_rt82:
  s_sleep 1
  s_sub_u32 s58, s58, 1
  s_cbranch_scc0 L_w46
  s_branch L_fin
L_rt83:
  s_sleep 1
  s_sub_u32 s58, s58, 1
  s_cbranch_scc0 L_bg48
  s_branch L_fin
L_rt84:
  s_sub_u32 s58, s58, 1
  s_cbranch_scc0 L_w51
  s_branch L_fin
L_rt85:
  s_sub_u32 s58, s58, 1
  s_cbranch_scc0 L_w53
  s_branch L_fin
L_rt86:
  s_sleep 1
  s_sub_u32 s58, s58, 1
  s_cbranch_scc0 L_pp55
  s_branch L_fin
L_rt87:
  s_sub_u32 s58, s58, 1
  s_cbranch_scc0 L_h257
  s_branch L_fin
L_rt88:
  s_sub_u32 s58, s58, 1
  s_cbranch_scc0 L_w59
  s_branch L_fin
L_rt89:
  s_sub_u32 s58, s58, 1
  s_cbranch_scc0 L_gu61
  s_branch L_fin
L_last:
.section .rodata,"a"
.p2align 6
.amdhsa_kernel adaLN_cond__sliding_block_cached__geglu_ffn__decode_kernel
  .amdhsa_next_free_vgpr 168
  .amdhsa_next_free_sgpr 102
  .amdhsa_accum_offset 168
  .amdhsa_group_segment_fixed_size 0
  .amdhsa_kernarg_size 112
  .amdhsa_user_sgpr_count 2
  .amdhsa_user_sgpr_kernarg_segment_ptr 1
  .amdhsa_system_sgpr_workgroup_id_x 1
.end_amdhsa_kernel
```
